```python
import torch

def _softmax(x, axis=-1):
    return torch.softmax(x, dim=axis)

def _gelu(x):
    return torch.nn.functional.gelu(x, approximate='tanh')

def _silu(x):
    return torch.nn.functional.silu(x)

def _sigmoid(x):
    return torch.sigmoid(x)

def _layernorm(x, axis=-1, eps=1e-05):
    m = x.mean(dim=axis, keepdim=True)
    v = x.var(dim=axis, keepdim=True, unbiased=False)
    return (x - m) / torch.sqrt(v + eps)

def _scatter_add(tgt, idx, src, axis=0):
    return tgt.clone().index_add_(axis, idx, src)

def _segment_sum(src, seg, n):
    out = torch.zeros((n,) + src.shape[1:], dtype=src.dtype)
    return out.index_add_(0, seg, src)

def _pad(x, pw):
    flat = tuple((v for pair in reversed(pw) for v in pair))
    return torch.nn.functional.pad(x, flat)
kernel_name = 'adaLN_cond__mha_block_cached__glu_gated_glu__decode'

def setup_inputs():

    _w = lambda a: (lambda t: t.to(torch.bfloat16) if t.is_floating_point() else t)(torch.as_tensor(a))

    def _A_setup():
        B, Sq, D = (4, 1, 512)
        H, Sk, Dh = (32, 8192, 128)
        return {'x': _w((lambda *s: torch.randn(*s, dtype=torch.bfloat16) * 0.05)(B, Sq, D)), 'k_cache': _w((lambda *s: torch.randn(*s, dtype=torch.bfloat16) * 3.2)(B, H, Sk, Dh)), 'v_cache': _w((lambda *s: torch.randn(*s, dtype=torch.bfloat16) * 0.4)(B, H, Sk, Dh)), 'wq': _w((lambda *s: torch.randn(*s, dtype=torch.bfloat16) * 3.2)(D, H * Dh) * D ** (-0.5)), 'wo': _w((lambda *s: torch.randn(*s, dtype=torch.bfloat16) * 0.4)(H * Dh, D) * (H * Dh) ** (-0.5))}
    _A_in = _A_setup()

    def _B_setup():
        B, S, D, F = (4, 1, 512, 1792)
        return {'x': _w((lambda *s: torch.randn(*s, dtype=torch.bfloat16) * 0.05)(B, S, D)), 'w_gate': _w((lambda *s: torch.randn(*s, dtype=torch.bfloat16) * 0.05)(D, F)), 'w_up': _w((lambda *s: torch.randn(*s, dtype=torch.bfloat16) * 0.05)(D, F)), 'w_down': _w((lambda *s: torch.randn(*s, dtype=torch.bfloat16) * 0.05)(F, D))}
    _B_in = _B_setup()
    return {'A_x': _A_in['x'], 'A_k_cache': _A_in['k_cache'], 'A_v_cache': _A_in['v_cache'], 'A_wq': _A_in['wq'], 'A_wo': _A_in['wo'], 'B_x': _B_in['x'], 'B_w_gate': _B_in['w_gate'], 'B_w_up': _B_in['w_up'], 'B_w_down': _B_in['w_down'], 'c': _w((lambda *s: torch.randn(*s, dtype=torch.bfloat16) * 0.1)(4, 512) * 8.0), 'w_mod': _w((lambda *s: torch.randn(*s, dtype=torch.bfloat16) * 0.1)(512, 6 * 512) * 512 ** (-0.5) * 8.0)}

def reference(A_x, A_k_cache, A_v_cache, A_wq, A_wo, B_x, B_w_gate, B_w_up, B_w_down, c, w_mod):

    def _A_ref(x, k_cache, v_cache, wq, wo):
        B, Sq, D = x.shape
        H, Dh = (32, 128)
        q = (lambda x, *d: x.permute(*d))((x @ wq).reshape(B, Sq, H, Dh), 0, 2, 1, 3)
        scores = torch.einsum('bhqd,bhkd->bhqk', q, k_cache) * Dh ** (-0.5)
        p = _softmax(scores, axis=-1)
        o = torch.einsum('bhqk,bhkd->bhqd', p, v_cache)
        return (lambda x, *d: x.permute(*d))(o, 0, 2, 1, 3).reshape(B, Sq, H * Dh) @ wo

    def _B_ref(x, w_gate, w_up, w_down):
        g = torch.einsum('bsd,df->bsf', x, w_gate)
        u = torch.einsum('bsd,df->bsf', x, w_up)
        h = _sigmoid(g) * u
        return torch.einsum('bsf,fd->bsd', h, w_down)
    x = A_x
    mod = (_silu(c) @ w_mod).reshape(c.shape[0], 6, 1, -1)
    sa, ca, ga, sb, cb, gb = (mod[:, 0].clone(), mod[:, 1].clone(), mod[:, 2].clone(), mod[:, 3].clone(), mod[:, 4].clone(), mod[:, 5].clone())
    h = _layernorm(x, axis=-1) * (1 + ca) + sa
    x = x + ga * _A_ref(h, A_k_cache, A_v_cache, A_wq, A_wo)
    h = _layernorm(x, axis=-1) * (1 + cb) + sb
    x = x + gb * _B_ref(h, B_w_gate, B_w_up, B_w_down)
    return x
```

```asm
; @launch grid=(256,1,1) block=(768,1,1) lds=129536
.amdgcn_target "amdgcn-amd-amdhsa--gfx950"
.text
.globl adaLN_cond__mha_block_cached__glu_gated_glu__decode_kernel
.p2align 8
.type adaLN_cond__mha_block_cached__glu_gated_glu__decode_kernel,@function
adaLN_cond__mha_block_cached__glu_gated_glu__decode_kernel:
    s_cmp_ge_u32 s2, 256
    s_cbranch_scc1 END
    s_load_dwordx16 s[16:31], s[0:1], 0
    s_load_dwordx8 s[32:39], s[0:1], 64
    s_load_dwordx4 s[40:43], s[0:1], 96
    v_lshrrev_b32 v1, 6, v0
    v_and_b32 v0, 63, v0
    v_readfirstlane_b32 s3, v1
    s_and_b32 s6, s2, 31
    s_lshr_b32 s5, s2, 5
    s_and_b32 s5, s5, 3
    s_and_b32 s7, s2, 127
    s_lshl_b32 s7, s7, 21
    s_lshr_b32 s8, s2, 7
    s_lshl_b32 s8, s8, 20
    s_add_u32 s7, s7, s8
    s_mov_b32 s60, 0xcccccccc
    s_mov_b32 s61, 0xcccccccc
    s_mov_b32 s62, 0xaaaaaaaa
    s_mov_b32 s63, 0xaaaaaaaa
    s_mov_b32 s74, 0x3fb8aa3b
    s_cmp_ge_u32 s3, 8
    s_waitcnt lgkmcnt(0)
    s_cbranch_scc1 HELPER
    s_add_u32 s44, s18, s7
    s_addc_u32 s45, s19, 0
    s_mov_b32 s46, 0x100000
    s_mov_b32 s47, 0x00020000
    s_add_u32 s48, s20, s7
    s_addc_u32 s49, s21, 0
    s_lshl_b32 s8, s3, 12
    v_lshlrev_b32 v1, 4, v0
    v_add_u32 v1, s8, v1
    s_mov_b32 s50, 0
    s_waitcnt vmcnt(2)
    buffer_load_dwordx4 v[32:35], v1, s[44:47], s50 offen offset:0 nt
    s_waitcnt vmcnt(2)
    buffer_load_dwordx4 v[36:39], v1, s[44:47], s50 offen offset:1024 nt
    s_waitcnt vmcnt(2)
    buffer_load_dwordx4 v[40:43], v1, s[44:47], s50 offen offset:2048 nt
    s_barrier
    s_waitcnt vmcnt(2)
    buffer_load_dwordx4 v[44:47], v1, s[44:47], s50 offen offset:3072 nt
    s_add_u32 s50, s50, 0x8000
    s_waitcnt vmcnt(2)
    buffer_load_dwordx4 v[48:51], v1, s[44:47], s50 offen offset:0 nt
    s_waitcnt vmcnt(2)
    buffer_load_dwordx4 v[52:55], v1, s[44:47], s50 offen offset:1024 nt
    s_waitcnt vmcnt(2)
    buffer_load_dwordx4 v[56:59], v1, s[44:47], s50 offen offset:2048 nt
    s_waitcnt vmcnt(2)
    buffer_load_dwordx4 v[60:63], v1, s[44:47], s50 offen offset:3072 nt
    s_add_u32 s50, s50, 0x8000
    s_waitcnt vmcnt(2)
    buffer_load_dwordx4 v[64:67], v1, s[44:47], s50 offen offset:0 nt
    s_waitcnt vmcnt(2)
    buffer_load_dwordx4 v[68:71], v1, s[44:47], s50 offen offset:1024 nt
    s_waitcnt vmcnt(2)
    buffer_load_dwordx4 v[72:75], v1, s[44:47], s50 offen offset:2048 nt
    s_waitcnt vmcnt(2)
    buffer_load_dwordx4 v[76:79], v1, s[44:47], s50 offen offset:3072 nt
    s_add_u32 s50, s50, 0x8000
    s_waitcnt vmcnt(2)
    buffer_load_dwordx4 v[80:83], v1, s[44:47], s50 offen offset:0 nt
    s_waitcnt vmcnt(2)
    buffer_load_dwordx4 v[84:87], v1, s[44:47], s50 offen offset:1024 nt
    s_waitcnt vmcnt(2)
    buffer_load_dwordx4 v[88:91], v1, s[44:47], s50 offen offset:2048 nt
    s_waitcnt vmcnt(2)
    buffer_load_dwordx4 v[92:95], v1, s[44:47], s50 offen offset:3072 nt
    s_add_u32 s50, s50, 0x8000
    s_waitcnt vmcnt(2)
    buffer_load_dwordx4 v[96:99], v1, s[44:47], s50 offen offset:0 nt
    s_waitcnt vmcnt(2)
    buffer_load_dwordx4 v[100:103], v1, s[44:47], s50 offen offset:1024 nt
    s_waitcnt vmcnt(2)
    buffer_load_dwordx4 v[104:107], v1, s[44:47], s50 offen offset:2048 nt
    s_waitcnt vmcnt(2)
    buffer_load_dwordx4 v[108:111], v1, s[44:47], s50 offen offset:3072 nt
    s_add_u32 s50, s50, 0x8000
    s_waitcnt vmcnt(2)
    buffer_load_dwordx4 v[112:115], v1, s[44:47], s50 offen offset:0 nt
    s_waitcnt vmcnt(2)
    buffer_load_dwordx4 v[116:119], v1, s[44:47], s50 offen offset:1024 nt
    s_waitcnt vmcnt(2)
    buffer_load_dwordx4 v[120:123], v1, s[44:47], s50 offen offset:2048 nt
    s_waitcnt vmcnt(2)
    buffer_load_dwordx4 v[124:127], v1, s[44:47], s50 offen offset:3072 nt
    s_add_u32 s50, s50, 0x8000
    s_waitcnt vmcnt(2)
    buffer_load_dwordx4 v[128:131], v1, s[44:47], s50 offen offset:0 nt
    s_waitcnt vmcnt(2)
    buffer_load_dwordx4 v[132:135], v1, s[44:47], s50 offen offset:1024 nt
    s_waitcnt vmcnt(2)
    buffer_load_dwordx4 v[136:139], v1, s[44:47], s50 offen offset:2048 nt
    s_waitcnt vmcnt(2)
    buffer_load_dwordx4 v[140:143], v1, s[44:47], s50 offen offset:3072 nt
    s_add_u32 s50, s50, 0x8000
    s_waitcnt vmcnt(2)
    buffer_load_dwordx4 v[144:147], v1, s[44:47], s50 offen offset:0 nt
    s_waitcnt vmcnt(2)
    buffer_load_dwordx4 v[148:151], v1, s[44:47], s50 offen offset:1024 nt
    s_waitcnt vmcnt(2)
    buffer_load_dwordx4 v[152:155], v1, s[44:47], s50 offen offset:2048 nt
    s_waitcnt vmcnt(2)
    buffer_load_dwordx4 v[156:159], v1, s[44:47], s50 offen offset:3072 nt
    s_add_u32 s50, s50, 0x8000
    s_barrier
    v_and_b32 v2, 15, v0
    v_lshlrev_b32 v2, 5, v2
    v_add_u32 v2, 115200, v2
    ds_read_b128 v[16:19], v2 offset:0
    ds_read_b128 v[20:23], v2 offset:16
    ds_read_b128 v[24:27], v2 offset:512
    ds_read_b128 v[28:31], v2 offset:528
    ds_read_b128 v[8:11], v2 offset:1024
    ds_read_b128 v[12:15], v2 offset:1040
    ds_read_b128 v[160:163], v2 offset:1536
    ds_read_b128 v[164:167], v2 offset:1552
    s_waitcnt lgkmcnt(0)
    v_add_f32 v16, v16, v24
    v_add_f32 v8, v8, v160
    v_add_f32 v17, v17, v25
    v_add_f32 v9, v9, v161
    v_add_f32 v18, v18, v26
    v_add_f32 v10, v10, v162
    v_add_f32 v19, v19, v27
    v_add_f32 v11, v11, v163
    v_add_f32 v20, v20, v28
    v_add_f32 v12, v12, v164
    v_add_f32 v21, v21, v29
    v_add_f32 v13, v13, v165
    v_add_f32 v22, v22, v30
    v_add_f32 v14, v14, v166
    v_add_f32 v23, v23, v31
    v_add_f32 v15, v15, v167
    v_add_f32 v16, v16, v8
    v_add_f32 v17, v17, v9
    v_add_f32 v18, v18, v10
    v_add_f32 v19, v19, v11
    v_add_f32 v20, v20, v12
    v_add_f32 v21, v21, v13
    v_add_f32 v22, v22, v14
    v_add_f32 v23, v23, v15
    v_cvt_pk_bf16_f32 v4, v16, v17
    v_cvt_pk_bf16_f32 v5, v18, v19
    v_cvt_pk_bf16_f32 v6, v20, v21
    v_cvt_pk_bf16_f32 v7, v22, v23
    v_and_b32 v3, 1, v0
    v_lshlrev_b32 v3, 4, v3
    v_mov_b32 v2, 0xffff
    v_lshlrev_b32 v2, v3, v2
    v_and_b32 v3, 15, v0
    v_lshrrev_b32 v3, 1, v3
    v_cmp_eq_u32 vcc, 0, v3
    s_nop 1
    v_cndmask_b32 v164, 0, v2, vcc
    v_cmp_eq_u32 vcc, 1, v3
    s_nop 1
    v_cndmask_b32 v165, 0, v2, vcc
    v_cmp_eq_u32 vcc, 2, v3
    s_nop 1
    v_cndmask_b32 v166, 0, v2, vcc
    v_cmp_eq_u32 vcc, 3, v3
    s_nop 1
    v_cndmask_b32 v167, 0, v2, vcc
    v_dot2_f32_bf16 v16, v32, v4, 0
    v_dot2_f32_bf16 v16, v33, v5, v16
    v_dot2_f32_bf16 v16, v34, v6, v16
    v_dot2_f32_bf16 v16, v35, v7, v16
    s_waitcnt vmcnt(2)
    buffer_load_dwordx4 v[32:35], v1, s[44:47], s50 offen offset:0 nt
    v_dot2_f32_bf16 v17, v36, v4, 0
    v_dot2_f32_bf16 v17, v37, v5, v17
    v_dot2_f32_bf16 v17, v38, v6, v17
    v_dot2_f32_bf16 v17, v39, v7, v17
    s_waitcnt vmcnt(2)
    buffer_load_dwordx4 v[36:39], v1, s[44:47], s50 offen offset:1024 nt
    v_dot2_f32_bf16 v18, v40, v4, 0
    v_dot2_f32_bf16 v18, v41, v5, v18
    v_dot2_f32_bf16 v18, v42, v6, v18
    v_dot2_f32_bf16 v18, v43, v7, v18
    s_waitcnt vmcnt(2)
    buffer_load_dwordx4 v[40:43], v1, s[44:47], s50 offen offset:2048 nt
    v_dot2_f32_bf16 v19, v44, v4, 0
    v_dot2_f32_bf16 v19, v45, v5, v19
    v_dot2_f32_bf16 v19, v46, v6, v19
    v_dot2_f32_bf16 v19, v47, v7, v19
    s_waitcnt vmcnt(2)
    buffer_load_dwordx4 v[44:47], v1, s[44:47], s50 offen offset:3072 nt
    s_add_u32 s50, s50, 0x8000
    v_dot2_f32_bf16 v20, v48, v4, 0
    v_dot2_f32_bf16 v20, v49, v5, v20
    v_dot2_f32_bf16 v20, v50, v6, v20
    v_dot2_f32_bf16 v20, v51, v7, v20
    s_waitcnt vmcnt(2)
    buffer_load_dwordx4 v[48:51], v1, s[44:47], s50 offen offset:0 nt
    v_dot2_f32_bf16 v21, v52, v4, 0
    v_dot2_f32_bf16 v21, v53, v5, v21
    v_dot2_f32_bf16 v21, v54, v6, v21
    v_dot2_f32_bf16 v21, v55, v7, v21
    s_waitcnt vmcnt(2)
    buffer_load_dwordx4 v[52:55], v1, s[44:47], s50 offen offset:1024 nt
    v_dot2_f32_bf16 v22, v56, v4, 0
    v_dot2_f32_bf16 v22, v57, v5, v22
    v_dot2_f32_bf16 v22, v58, v6, v22
    v_dot2_f32_bf16 v22, v59, v7, v22
    s_waitcnt vmcnt(2)
    buffer_load_dwordx4 v[56:59], v1, s[44:47], s50 offen offset:2048 nt
    v_dot2_f32_bf16 v23, v60, v4, 0
    v_dot2_f32_bf16 v23, v61, v5, v23
    v_dot2_f32_bf16 v23, v62, v6, v23
    v_dot2_f32_bf16 v23, v63, v7, v23
    s_waitcnt vmcnt(2)
    buffer_load_dwordx4 v[60:63], v1, s[44:47], s50 offen offset:3072 nt
    s_add_u32 s50, s50, 0x8000
    v_dot2_f32_bf16 v24, v64, v4, 0
    v_dot2_f32_bf16 v24, v65, v5, v24
    v_dot2_f32_bf16 v24, v66, v6, v24
    v_dot2_f32_bf16 v24, v67, v7, v24
    s_waitcnt vmcnt(2)
    buffer_load_dwordx4 v[64:67], v1, s[44:47], s50 offen offset:0 nt
    v_dot2_f32_bf16 v25, v68, v4, 0
    v_dot2_f32_bf16 v25, v69, v5, v25
    v_dot2_f32_bf16 v25, v70, v6, v25
    v_dot2_f32_bf16 v25, v71, v7, v25
    s_waitcnt vmcnt(2)
    buffer_load_dwordx4 v[68:71], v1, s[44:47], s50 offen offset:1024 nt
    v_dot2_f32_bf16 v26, v72, v4, 0
    v_dot2_f32_bf16 v26, v73, v5, v26
    v_dot2_f32_bf16 v26, v74, v6, v26
    v_dot2_f32_bf16 v26, v75, v7, v26
    s_waitcnt vmcnt(2)
    buffer_load_dwordx4 v[72:75], v1, s[44:47], s50 offen offset:2048 nt
    v_dot2_f32_bf16 v27, v76, v4, 0
    v_dot2_f32_bf16 v27, v77, v5, v27
    v_dot2_f32_bf16 v27, v78, v6, v27
    v_dot2_f32_bf16 v27, v79, v7, v27
    s_waitcnt vmcnt(2)
    buffer_load_dwordx4 v[76:79], v1, s[44:47], s50 offen offset:3072 nt
    s_add_u32 s50, s50, 0x8000
    v_dot2_f32_bf16 v28, v80, v4, 0
    v_dot2_f32_bf16 v28, v81, v5, v28
    v_dot2_f32_bf16 v28, v82, v6, v28
    v_dot2_f32_bf16 v28, v83, v7, v28
    s_waitcnt vmcnt(2)
    buffer_load_dwordx4 v[80:83], v1, s[44:47], s50 offen offset:0 nt
    v_dot2_f32_bf16 v29, v84, v4, 0
    v_dot2_f32_bf16 v29, v85, v5, v29
    v_dot2_f32_bf16 v29, v86, v6, v29
    v_dot2_f32_bf16 v29, v87, v7, v29
    s_waitcnt vmcnt(2)
    buffer_load_dwordx4 v[84:87], v1, s[44:47], s50 offen offset:1024 nt
    v_dot2_f32_bf16 v30, v88, v4, 0
    v_dot2_f32_bf16 v30, v89, v5, v30
    v_dot2_f32_bf16 v30, v90, v6, v30
    v_dot2_f32_bf16 v30, v91, v7, v30
    s_waitcnt vmcnt(2)
    buffer_load_dwordx4 v[88:91], v1, s[44:47], s50 offen offset:2048 nt
    v_dot2_f32_bf16 v31, v92, v4, 0
    v_dot2_f32_bf16 v31, v93, v5, v31
    v_dot2_f32_bf16 v31, v94, v6, v31
    v_dot2_f32_bf16 v31, v95, v7, v31
    v_add_f32_dpp v16, v16, v16 row_ror:8 row_mask:0xf bank_mask:0x3
    v_add_f32_dpp v17, v17, v17 row_ror:8 row_mask:0xf bank_mask:0x3
    v_add_f32_dpp v18, v18, v18 row_ror:8 row_mask:0xf bank_mask:0x3
    v_add_f32_dpp v19, v19, v19 row_ror:8 row_mask:0xf bank_mask:0x3
    v_add_f32_dpp v20, v20, v20 row_ror:8 row_mask:0xf bank_mask:0x3
    v_add_f32_dpp v21, v21, v21 row_ror:8 row_mask:0xf bank_mask:0x3
    v_add_f32_dpp v22, v22, v22 row_ror:8 row_mask:0xf bank_mask:0x3
    v_add_f32_dpp v23, v23, v23 row_ror:8 row_mask:0xf bank_mask:0x3
    v_add_f32_dpp v16, v24, v24 row_ror:8 row_mask:0xf bank_mask:0xc
    v_add_f32_dpp v17, v25, v25 row_ror:8 row_mask:0xf bank_mask:0xc
    v_add_f32_dpp v18, v26, v26 row_ror:8 row_mask:0xf bank_mask:0xc
    v_add_f32_dpp v19, v27, v27 row_ror:8 row_mask:0xf bank_mask:0xc
    v_add_f32_dpp v20, v28, v28 row_ror:8 row_mask:0xf bank_mask:0xc
    v_add_f32_dpp v21, v29, v29 row_ror:8 row_mask:0xf bank_mask:0xc
    v_add_f32_dpp v22, v30, v30 row_ror:8 row_mask:0xf bank_mask:0xc
    v_add_f32_dpp v23, v31, v31 row_ror:8 row_mask:0xf bank_mask:0xc
    v_add_f32_dpp v16, v16, v16 row_shl:4 row_mask:0xf bank_mask:0x5
    v_add_f32_dpp v17, v17, v17 row_shl:4 row_mask:0xf bank_mask:0x5
    v_add_f32_dpp v18, v18, v18 row_shl:4 row_mask:0xf bank_mask:0x5
    v_add_f32_dpp v19, v19, v19 row_shl:4 row_mask:0xf bank_mask:0x5
    v_add_f32_dpp v16, v20, v20 row_shr:4 row_mask:0xf bank_mask:0xa
    v_add_f32_dpp v17, v21, v21 row_shr:4 row_mask:0xf bank_mask:0xa
    v_add_f32_dpp v18, v22, v22 row_shr:4 row_mask:0xf bank_mask:0xa
    v_add_f32_dpp v19, v23, v23 row_shr:4 row_mask:0xf bank_mask:0xa
    v_cndmask_b32_e64 v2, v18, v16, s[60:61]
    v_cndmask_b32_e64 v16, v16, v18, s[60:61]
    v_cndmask_b32_e64 v3, v19, v17, s[60:61]
    v_cndmask_b32_e64 v17, v17, v19, s[60:61]
    v_add_f32_dpp v16, v2, v16 quad_perm:[2,3,0,1] row_mask:0xf bank_mask:0xf
    s_nop 0
    v_add_f32_dpp v17, v3, v17 quad_perm:[2,3,0,1] row_mask:0xf bank_mask:0xf
    v_cndmask_b32_e64 v2, v17, v16, s[62:63]
    v_cndmask_b32_e64 v16, v16, v17, s[62:63]
    s_nop 1
    v_add_f32_dpp v16, v2, v16 quad_perm:[1,0,3,2] row_mask:0xf bank_mask:0xf
    v_mov_b32 v14, v16
    s_waitcnt vmcnt(2)
    buffer_load_dwordx4 v[92:95], v1, s[44:47], s50 offen offset:3072 nt
    s_add_u32 s50, s50, 0x8000
    v_dot2_f32_bf16 v16, v96, v4, 0
    v_dot2_f32_bf16 v16, v97, v5, v16
    v_dot2_f32_bf16 v16, v98, v6, v16
    v_dot2_f32_bf16 v16, v99, v7, v16
    s_waitcnt vmcnt(2)
    buffer_load_dwordx4 v[96:99], v1, s[44:47], s50 offen offset:0 nt
    v_dot2_f32_bf16 v17, v100, v4, 0
    v_dot2_f32_bf16 v17, v101, v5, v17
    v_dot2_f32_bf16 v17, v102, v6, v17
    v_dot2_f32_bf16 v17, v103, v7, v17
    s_waitcnt vmcnt(2)
    buffer_load_dwordx4 v[100:103], v1, s[44:47], s50 offen offset:1024 nt
    v_dot2_f32_bf16 v18, v104, v4, 0
    v_dot2_f32_bf16 v18, v105, v5, v18
    v_dot2_f32_bf16 v18, v106, v6, v18
    v_dot2_f32_bf16 v18, v107, v7, v18
    s_waitcnt vmcnt(2)
    buffer_load_dwordx4 v[104:107], v1, s[44:47], s50 offen offset:2048 nt
    v_dot2_f32_bf16 v19, v108, v4, 0
    v_dot2_f32_bf16 v19, v109, v5, v19
    v_dot2_f32_bf16 v19, v110, v6, v19
    v_dot2_f32_bf16 v19, v111, v7, v19
    s_waitcnt vmcnt(2)
    buffer_load_dwordx4 v[108:111], v1, s[44:47], s50 offen offset:3072 nt
    s_add_u32 s50, s50, 0x8000
    v_dot2_f32_bf16 v20, v112, v4, 0
    v_dot2_f32_bf16 v20, v113, v5, v20
    v_dot2_f32_bf16 v20, v114, v6, v20
    v_dot2_f32_bf16 v20, v115, v7, v20
    s_waitcnt vmcnt(2)
    buffer_load_dwordx4 v[112:115], v1, s[44:47], s50 offen offset:0 nt
    v_dot2_f32_bf16 v21, v116, v4, 0
    v_dot2_f32_bf16 v21, v117, v5, v21
    v_dot2_f32_bf16 v21, v118, v6, v21
    v_dot2_f32_bf16 v21, v119, v7, v21
    s_waitcnt vmcnt(2)
    buffer_load_dwordx4 v[116:119], v1, s[44:47], s50 offen offset:1024 nt
    v_dot2_f32_bf16 v22, v120, v4, 0
    v_dot2_f32_bf16 v22, v121, v5, v22
    v_dot2_f32_bf16 v22, v122, v6, v22
    v_dot2_f32_bf16 v22, v123, v7, v22
    s_waitcnt vmcnt(2)
    buffer_load_dwordx4 v[120:123], v1, s[44:47], s50 offen offset:2048 nt
    v_dot2_f32_bf16 v23, v124, v4, 0
    v_dot2_f32_bf16 v23, v125, v5, v23
    v_dot2_f32_bf16 v23, v126, v6, v23
    v_dot2_f32_bf16 v23, v127, v7, v23
    s_waitcnt vmcnt(2)
    buffer_load_dwordx4 v[124:127], v1, s[44:47], s50 offen offset:3072 nt
    s_add_u32 s50, s50, 0x8000
    v_dot2_f32_bf16 v24, v128, v4, 0
    v_dot2_f32_bf16 v24, v129, v5, v24
    v_dot2_f32_bf16 v24, v130, v6, v24
    v_dot2_f32_bf16 v24, v131, v7, v24
    s_waitcnt vmcnt(2)
    buffer_load_dwordx4 v[128:131], v1, s[44:47], s50 offen offset:0 nt
    v_dot2_f32_bf16 v25, v132, v4, 0
    v_dot2_f32_bf16 v25, v133, v5, v25
    v_dot2_f32_bf16 v25, v134, v6, v25
    v_dot2_f32_bf16 v25, v135, v7, v25
    s_waitcnt vmcnt(2)
    buffer_load_dwordx4 v[132:135], v1, s[44:47], s50 offen offset:1024 nt
    v_dot2_f32_bf16 v26, v136, v4, 0
    v_dot2_f32_bf16 v26, v137, v5, v26
    v_dot2_f32_bf16 v26, v138, v6, v26
    v_dot2_f32_bf16 v26, v139, v7, v26
    s_waitcnt vmcnt(2)
    buffer_load_dwordx4 v[136:139], v1, s[44:47], s50 offen offset:2048 nt
    v_dot2_f32_bf16 v27, v140, v4, 0
    v_dot2_f32_bf16 v27, v141, v5, v27
    v_dot2_f32_bf16 v27, v142, v6, v27
    v_dot2_f32_bf16 v27, v143, v7, v27
    s_waitcnt vmcnt(2)
    buffer_load_dwordx4 v[140:143], v1, s[44:47], s50 offen offset:3072 nt
    s_add_u32 s50, s50, 0x8000
    v_dot2_f32_bf16 v28, v144, v4, 0
    v_dot2_f32_bf16 v28, v145, v5, v28
    v_dot2_f32_bf16 v28, v146, v6, v28
    v_dot2_f32_bf16 v28, v147, v7, v28
    v_dot2_f32_bf16 v29, v148, v4, 0
    v_dot2_f32_bf16 v29, v149, v5, v29
    v_dot2_f32_bf16 v29, v150, v6, v29
    v_dot2_f32_bf16 v29, v151, v7, v29
    v_dot2_f32_bf16 v30, v152, v4, 0
    v_dot2_f32_bf16 v30, v153, v5, v30
    v_dot2_f32_bf16 v30, v154, v6, v30
    v_dot2_f32_bf16 v30, v155, v7, v30
    v_dot2_f32_bf16 v31, v156, v4, 0
    v_dot2_f32_bf16 v31, v157, v5, v31
    v_dot2_f32_bf16 v31, v158, v6, v31
    v_dot2_f32_bf16 v31, v159, v7, v31
    v_add_f32_dpp v16, v16, v16 row_ror:8 row_mask:0xf bank_mask:0x3
    v_add_f32_dpp v17, v17, v17 row_ror:8 row_mask:0xf bank_mask:0x3
    v_add_f32_dpp v18, v18, v18 row_ror:8 row_mask:0xf bank_mask:0x3
    v_add_f32_dpp v19, v19, v19 row_ror:8 row_mask:0xf bank_mask:0x3
    v_add_f32_dpp v20, v20, v20 row_ror:8 row_mask:0xf bank_mask:0x3
    v_add_f32_dpp v21, v21, v21 row_ror:8 row_mask:0xf bank_mask:0x3
    v_add_f32_dpp v22, v22, v22 row_ror:8 row_mask:0xf bank_mask:0x3
    v_add_f32_dpp v23, v23, v23 row_ror:8 row_mask:0xf bank_mask:0x3
    v_add_f32_dpp v16, v24, v24 row_ror:8 row_mask:0xf bank_mask:0xc
    v_add_f32_dpp v17, v25, v25 row_ror:8 row_mask:0xf bank_mask:0xc
    v_add_f32_dpp v18, v26, v26 row_ror:8 row_mask:0xf bank_mask:0xc
    v_add_f32_dpp v19, v27, v27 row_ror:8 row_mask:0xf bank_mask:0xc
    v_add_f32_dpp v20, v28, v28 row_ror:8 row_mask:0xf bank_mask:0xc
    v_add_f32_dpp v21, v29, v29 row_ror:8 row_mask:0xf bank_mask:0xc
    v_add_f32_dpp v22, v30, v30 row_ror:8 row_mask:0xf bank_mask:0xc
    v_add_f32_dpp v23, v31, v31 row_ror:8 row_mask:0xf bank_mask:0xc
    v_add_f32_dpp v16, v16, v16 row_shl:4 row_mask:0xf bank_mask:0x5
    v_add_f32_dpp v17, v17, v17 row_shl:4 row_mask:0xf bank_mask:0x5
    v_add_f32_dpp v18, v18, v18 row_shl:4 row_mask:0xf bank_mask:0x5
    v_add_f32_dpp v19, v19, v19 row_shl:4 row_mask:0xf bank_mask:0x5
    v_add_f32_dpp v16, v20, v20 row_shr:4 row_mask:0xf bank_mask:0xa
    v_add_f32_dpp v17, v21, v21 row_shr:4 row_mask:0xf bank_mask:0xa
    v_add_f32_dpp v18, v22, v22 row_shr:4 row_mask:0xf bank_mask:0xa
    v_add_f32_dpp v19, v23, v23 row_shr:4 row_mask:0xf bank_mask:0xa
    v_cndmask_b32_e64 v2, v18, v16, s[60:61]
    v_cndmask_b32_e64 v16, v16, v18, s[60:61]
    v_cndmask_b32_e64 v3, v19, v17, s[60:61]
    v_cndmask_b32_e64 v17, v17, v19, s[60:61]
    v_add_f32_dpp v16, v2, v16 quad_perm:[2,3,0,1] row_mask:0xf bank_mask:0xf
    s_nop 0
    v_add_f32_dpp v17, v3, v17 quad_perm:[2,3,0,1] row_mask:0xf bank_mask:0xf
    v_cndmask_b32_e64 v2, v17, v16, s[62:63]
    v_cndmask_b32_e64 v16, v16, v17, s[62:63]
    s_nop 1
    v_add_f32_dpp v16, v2, v16 quad_perm:[1,0,3,2] row_mask:0xf bank_mask:0xf
    v_mov_b32 v15, v16
    s_mov_b32 s51, 3
KLOOP:
    v_mov_b32 v8, v10
    v_mov_b32 v9, v11
    v_mov_b32 v10, v12
    v_mov_b32 v11, v13
    v_mov_b32 v12, v14
    v_mov_b32 v13, v15
    v_dot2_f32_bf16 v16, v32, v4, 0
    v_dot2_f32_bf16 v16, v33, v5, v16
    v_dot2_f32_bf16 v16, v34, v6, v16
    v_dot2_f32_bf16 v16, v35, v7, v16
    s_waitcnt vmcnt(2)
    buffer_load_dwordx4 v[144:147], v1, s[44:47], s50 offen offset:0 nt
    v_dot2_f32_bf16 v17, v36, v4, 0
    v_dot2_f32_bf16 v17, v37, v5, v17
    v_dot2_f32_bf16 v17, v38, v6, v17
    v_dot2_f32_bf16 v17, v39, v7, v17
    s_waitcnt vmcnt(2)
    buffer_load_dwordx4 v[148:151], v1, s[44:47], s50 offen offset:1024 nt
    v_dot2_f32_bf16 v18, v40, v4, 0
    v_dot2_f32_bf16 v18, v41, v5, v18
    v_dot2_f32_bf16 v18, v42, v6, v18
    v_dot2_f32_bf16 v18, v43, v7, v18
    s_waitcnt vmcnt(2)
    buffer_load_dwordx4 v[152:155], v1, s[44:47], s50 offen offset:2048 nt
    v_dot2_f32_bf16 v19, v44, v4, 0
    v_dot2_f32_bf16 v19, v45, v5, v19
    v_dot2_f32_bf16 v19, v46, v6, v19
    v_dot2_f32_bf16 v19, v47, v7, v19
    s_waitcnt vmcnt(2)
    buffer_load_dwordx4 v[156:159], v1, s[44:47], s50 offen offset:3072 nt
    s_add_u32 s50, s50, 0x8000
    s_cmp_eq_u32 s51, 1
    s_cselect_b32 s44, s48, s44
    s_cselect_b32 s45, s49, s45
    s_cselect_b32 s50, 0, s50
    v_dot2_f32_bf16 v20, v48, v4, 0
    v_dot2_f32_bf16 v20, v49, v5, v20
    v_dot2_f32_bf16 v20, v50, v6, v20
    v_dot2_f32_bf16 v20, v51, v7, v20
    s_waitcnt vmcnt(2)
    buffer_load_dwordx4 v[32:35], v1, s[44:47], s50 offen offset:0 nt
    v_dot2_f32_bf16 v21, v52, v4, 0
    v_dot2_f32_bf16 v21, v53, v5, v21
    v_dot2_f32_bf16 v21, v54, v6, v21
    v_dot2_f32_bf16 v21, v55, v7, v21
    s_waitcnt vmcnt(2)
    buffer_load_dwordx4 v[36:39], v1, s[44:47], s50 offen offset:1024 nt
    v_dot2_f32_bf16 v22, v56, v4, 0
    v_dot2_f32_bf16 v22, v57, v5, v22
    v_dot2_f32_bf16 v22, v58, v6, v22
    v_dot2_f32_bf16 v22, v59, v7, v22
    s_waitcnt vmcnt(2)
    buffer_load_dwordx4 v[40:43], v1, s[44:47], s50 offen offset:2048 nt
    v_dot2_f32_bf16 v23, v60, v4, 0
    v_dot2_f32_bf16 v23, v61, v5, v23
    v_dot2_f32_bf16 v23, v62, v6, v23
    v_dot2_f32_bf16 v23, v63, v7, v23
    s_waitcnt vmcnt(2)
    buffer_load_dwordx4 v[44:47], v1, s[44:47], s50 offen offset:3072 nt
    s_add_u32 s50, s50, 0x8000
    v_dot2_f32_bf16 v24, v64, v4, 0
    v_dot2_f32_bf16 v24, v65, v5, v24
    v_dot2_f32_bf16 v24, v66, v6, v24
    v_dot2_f32_bf16 v24, v67, v7, v24
    s_waitcnt vmcnt(2)
    buffer_load_dwordx4 v[48:51], v1, s[44:47], s50 offen offset:0 nt
    v_dot2_f32_bf16 v25, v68, v4, 0
    v_dot2_f32_bf16 v25, v69, v5, v25
    v_dot2_f32_bf16 v25, v70, v6, v25
    v_dot2_f32_bf16 v25, v71, v7, v25
    s_waitcnt vmcnt(2)
    buffer_load_dwordx4 v[52:55], v1, s[44:47], s50 offen offset:1024 nt
    v_dot2_f32_bf16 v26, v72, v4, 0
    v_dot2_f32_bf16 v26, v73, v5, v26
    v_dot2_f32_bf16 v26, v74, v6, v26
    v_dot2_f32_bf16 v26, v75, v7, v26
    s_waitcnt vmcnt(2)
    buffer_load_dwordx4 v[56:59], v1, s[44:47], s50 offen offset:2048 nt
    v_dot2_f32_bf16 v27, v76, v4, 0
    v_dot2_f32_bf16 v27, v77, v5, v27
    v_dot2_f32_bf16 v27, v78, v6, v27
    v_dot2_f32_bf16 v27, v79, v7, v27
    s_waitcnt vmcnt(2)
    buffer_load_dwordx4 v[60:63], v1, s[44:47], s50 offen offset:3072 nt
    s_add_u32 s50, s50, 0x8000
    v_dot2_f32_bf16 v28, v80, v4, 0
    v_dot2_f32_bf16 v28, v81, v5, v28
    v_dot2_f32_bf16 v28, v82, v6, v28
    v_dot2_f32_bf16 v28, v83, v7, v28
    s_waitcnt vmcnt(2)
    buffer_load_dwordx4 v[64:67], v1, s[44:47], s50 offen offset:0 nt
    v_dot2_f32_bf16 v29, v84, v4, 0
    v_dot2_f32_bf16 v29, v85, v5, v29
    v_dot2_f32_bf16 v29, v86, v6, v29
    v_dot2_f32_bf16 v29, v87, v7, v29
    s_waitcnt vmcnt(2)
    buffer_load_dwordx4 v[68:71], v1, s[44:47], s50 offen offset:1024 nt
    v_dot2_f32_bf16 v30, v88, v4, 0
    v_dot2_f32_bf16 v30, v89, v5, v30
    v_dot2_f32_bf16 v30, v90, v6, v30
    v_dot2_f32_bf16 v30, v91, v7, v30
    s_waitcnt vmcnt(2)
    buffer_load_dwordx4 v[72:75], v1, s[44:47], s50 offen offset:2048 nt
    v_dot2_f32_bf16 v31, v92, v4, 0
    v_dot2_f32_bf16 v31, v93, v5, v31
    v_dot2_f32_bf16 v31, v94, v6, v31
    v_dot2_f32_bf16 v31, v95, v7, v31
    v_add_f32_dpp v16, v16, v16 row_ror:8 row_mask:0xf bank_mask:0x3
    v_add_f32_dpp v17, v17, v17 row_ror:8 row_mask:0xf bank_mask:0x3
    v_add_f32_dpp v18, v18, v18 row_ror:8 row_mask:0xf bank_mask:0x3
    v_add_f32_dpp v19, v19, v19 row_ror:8 row_mask:0xf bank_mask:0x3
    v_add_f32_dpp v20, v20, v20 row_ror:8 row_mask:0xf bank_mask:0x3
    v_add_f32_dpp v21, v21, v21 row_ror:8 row_mask:0xf bank_mask:0x3
    v_add_f32_dpp v22, v22, v22 row_ror:8 row_mask:0xf bank_mask:0x3
    v_add_f32_dpp v23, v23, v23 row_ror:8 row_mask:0xf bank_mask:0x3
    v_add_f32_dpp v16, v24, v24 row_ror:8 row_mask:0xf bank_mask:0xc
    v_add_f32_dpp v17, v25, v25 row_ror:8 row_mask:0xf bank_mask:0xc
    v_add_f32_dpp v18, v26, v26 row_ror:8 row_mask:0xf bank_mask:0xc
    v_add_f32_dpp v19, v27, v27 row_ror:8 row_mask:0xf bank_mask:0xc
    v_add_f32_dpp v20, v28, v28 row_ror:8 row_mask:0xf bank_mask:0xc
    v_add_f32_dpp v21, v29, v29 row_ror:8 row_mask:0xf bank_mask:0xc
    v_add_f32_dpp v22, v30, v30 row_ror:8 row_mask:0xf bank_mask:0xc
    v_add_f32_dpp v23, v31, v31 row_ror:8 row_mask:0xf bank_mask:0xc
    v_add_f32_dpp v16, v16, v16 row_shl:4 row_mask:0xf bank_mask:0x5
    v_add_f32_dpp v17, v17, v17 row_shl:4 row_mask:0xf bank_mask:0x5
    v_add_f32_dpp v18, v18, v18 row_shl:4 row_mask:0xf bank_mask:0x5
    v_add_f32_dpp v19, v19, v19 row_shl:4 row_mask:0xf bank_mask:0x5
    v_add_f32_dpp v16, v20, v20 row_shr:4 row_mask:0xf bank_mask:0xa
    v_add_f32_dpp v17, v21, v21 row_shr:4 row_mask:0xf bank_mask:0xa
    v_add_f32_dpp v18, v22, v22 row_shr:4 row_mask:0xf bank_mask:0xa
    v_add_f32_dpp v19, v23, v23 row_shr:4 row_mask:0xf bank_mask:0xa
    v_cndmask_b32_e64 v2, v18, v16, s[60:61]
    v_cndmask_b32_e64 v16, v16, v18, s[60:61]
    v_cndmask_b32_e64 v3, v19, v17, s[60:61]
    v_cndmask_b32_e64 v17, v17, v19, s[60:61]
    v_add_f32_dpp v16, v2, v16 quad_perm:[2,3,0,1] row_mask:0xf bank_mask:0xf
    s_nop 0
    v_add_f32_dpp v17, v3, v17 quad_perm:[2,3,0,1] row_mask:0xf bank_mask:0xf
    v_cndmask_b32_e64 v2, v17, v16, s[62:63]
    v_cndmask_b32_e64 v16, v16, v17, s[62:63]
    s_nop 1
    v_add_f32_dpp v16, v2, v16 quad_perm:[1,0,3,2] row_mask:0xf bank_mask:0xf
    v_mov_b32 v14, v16
    s_waitcnt vmcnt(2)
    buffer_load_dwordx4 v[76:79], v1, s[44:47], s50 offen offset:3072 nt
    s_add_u32 s50, s50, 0x8000
    v_dot2_f32_bf16 v16, v96, v4, 0
    v_dot2_f32_bf16 v16, v97, v5, v16
    v_dot2_f32_bf16 v16, v98, v6, v16
    v_dot2_f32_bf16 v16, v99, v7, v16
    s_waitcnt vmcnt(2)
    buffer_load_dwordx4 v[80:83], v1, s[44:47], s50 offen offset:0 nt
    v_dot2_f32_bf16 v17, v100, v4, 0
    v_dot2_f32_bf16 v17, v101, v5, v17
    v_dot2_f32_bf16 v17, v102, v6, v17
    v_dot2_f32_bf16 v17, v103, v7, v17
    s_waitcnt vmcnt(2)
    buffer_load_dwordx4 v[84:87], v1, s[44:47], s50 offen offset:1024 nt
    v_dot2_f32_bf16 v18, v104, v4, 0
    v_dot2_f32_bf16 v18, v105, v5, v18
    v_dot2_f32_bf16 v18, v106, v6, v18
    v_dot2_f32_bf16 v18, v107, v7, v18
    s_waitcnt vmcnt(2)
    buffer_load_dwordx4 v[88:91], v1, s[44:47], s50 offen offset:2048 nt
    v_dot2_f32_bf16 v19, v108, v4, 0
    v_dot2_f32_bf16 v19, v109, v5, v19
    v_dot2_f32_bf16 v19, v110, v6, v19
    v_dot2_f32_bf16 v19, v111, v7, v19
    s_waitcnt vmcnt(2)
    buffer_load_dwordx4 v[92:95], v1, s[44:47], s50 offen offset:3072 nt
    s_add_u32 s50, s50, 0x8000
    v_dot2_f32_bf16 v20, v112, v4, 0
    v_dot2_f32_bf16 v20, v113, v5, v20
    v_dot2_f32_bf16 v20, v114, v6, v20
    v_dot2_f32_bf16 v20, v115, v7, v20
    s_waitcnt vmcnt(2)
    buffer_load_dwordx4 v[96:99], v1, s[44:47], s50 offen offset:0 nt
    v_dot2_f32_bf16 v21, v116, v4, 0
    v_dot2_f32_bf16 v21, v117, v5, v21
    v_dot2_f32_bf16 v21, v118, v6, v21
    v_dot2_f32_bf16 v21, v119, v7, v21
    s_waitcnt vmcnt(2)
    buffer_load_dwordx4 v[100:103], v1, s[44:47], s50 offen offset:1024 nt
    v_dot2_f32_bf16 v22, v120, v4, 0
    v_dot2_f32_bf16 v22, v121, v5, v22
    v_dot2_f32_bf16 v22, v122, v6, v22
    v_dot2_f32_bf16 v22, v123, v7, v22
    s_waitcnt vmcnt(2)
    buffer_load_dwordx4 v[104:107], v1, s[44:47], s50 offen offset:2048 nt
    v_dot2_f32_bf16 v23, v124, v4, 0
    v_dot2_f32_bf16 v23, v125, v5, v23
    v_dot2_f32_bf16 v23, v126, v6, v23
    v_dot2_f32_bf16 v23, v127, v7, v23
    s_waitcnt vmcnt(2)
    buffer_load_dwordx4 v[108:111], v1, s[44:47], s50 offen offset:3072 nt
    s_add_u32 s50, s50, 0x8000
    v_dot2_f32_bf16 v24, v128, v4, 0
    v_dot2_f32_bf16 v24, v129, v5, v24
    v_dot2_f32_bf16 v24, v130, v6, v24
    v_dot2_f32_bf16 v24, v131, v7, v24
    s_waitcnt vmcnt(2)
    buffer_load_dwordx4 v[112:115], v1, s[44:47], s50 offen offset:0 nt
    v_dot2_f32_bf16 v25, v132, v4, 0
    v_dot2_f32_bf16 v25, v133, v5, v25
    v_dot2_f32_bf16 v25, v134, v6, v25
    v_dot2_f32_bf16 v25, v135, v7, v25
    s_waitcnt vmcnt(2)
    buffer_load_dwordx4 v[116:119], v1, s[44:47], s50 offen offset:1024 nt
    v_dot2_f32_bf16 v26, v136, v4, 0
    v_dot2_f32_bf16 v26, v137, v5, v26
    v_dot2_f32_bf16 v26, v138, v6, v26
    v_dot2_f32_bf16 v26, v139, v7, v26
    s_waitcnt vmcnt(2)
    buffer_load_dwordx4 v[120:123], v1, s[44:47], s50 offen offset:2048 nt
    v_dot2_f32_bf16 v27, v140, v4, 0
    v_dot2_f32_bf16 v27, v141, v5, v27
    v_dot2_f32_bf16 v27, v142, v6, v27
    v_dot2_f32_bf16 v27, v143, v7, v27
    s_waitcnt vmcnt(2)
    buffer_load_dwordx4 v[124:127], v1, s[44:47], s50 offen offset:3072 nt
    s_add_u32 s50, s50, 0x8000
    v_dot2_f32_bf16 v28, v144, v4, 0
    v_dot2_f32_bf16 v28, v145, v5, v28
    v_dot2_f32_bf16 v28, v146, v6, v28
    v_dot2_f32_bf16 v28, v147, v7, v28
    s_waitcnt vmcnt(2)
    buffer_load_dwordx4 v[128:131], v1, s[44:47], s50 offen offset:0 nt
    v_dot2_f32_bf16 v29, v148, v4, 0
    v_dot2_f32_bf16 v29, v149, v5, v29
    v_dot2_f32_bf16 v29, v150, v6, v29
    v_dot2_f32_bf16 v29, v151, v7, v29
    s_waitcnt vmcnt(2)
    buffer_load_dwordx4 v[132:135], v1, s[44:47], s50 offen offset:1024 nt
    v_dot2_f32_bf16 v30, v152, v4, 0
    v_dot2_f32_bf16 v30, v153, v5, v30
    v_dot2_f32_bf16 v30, v154, v6, v30
    v_dot2_f32_bf16 v30, v155, v7, v30
    s_waitcnt vmcnt(2)
    buffer_load_dwordx4 v[136:139], v1, s[44:47], s50 offen offset:2048 nt
    v_dot2_f32_bf16 v31, v156, v4, 0
    v_dot2_f32_bf16 v31, v157, v5, v31
    v_dot2_f32_bf16 v31, v158, v6, v31
    v_dot2_f32_bf16 v31, v159, v7, v31
    v_add_f32_dpp v16, v16, v16 row_ror:8 row_mask:0xf bank_mask:0x3
    v_add_f32_dpp v17, v17, v17 row_ror:8 row_mask:0xf bank_mask:0x3
    v_add_f32_dpp v18, v18, v18 row_ror:8 row_mask:0xf bank_mask:0x3
    v_add_f32_dpp v19, v19, v19 row_ror:8 row_mask:0xf bank_mask:0x3
    v_add_f32_dpp v20, v20, v20 row_ror:8 row_mask:0xf bank_mask:0x3
    v_add_f32_dpp v21, v21, v21 row_ror:8 row_mask:0xf bank_mask:0x3
    v_add_f32_dpp v22, v22, v22 row_ror:8 row_mask:0xf bank_mask:0x3
    v_add_f32_dpp v23, v23, v23 row_ror:8 row_mask:0xf bank_mask:0x3
    v_add_f32_dpp v16, v24, v24 row_ror:8 row_mask:0xf bank_mask:0xc
    v_add_f32_dpp v17, v25, v25 row_ror:8 row_mask:0xf bank_mask:0xc
    v_add_f32_dpp v18, v26, v26 row_ror:8 row_mask:0xf bank_mask:0xc
    v_add_f32_dpp v19, v27, v27 row_ror:8 row_mask:0xf bank_mask:0xc
    v_add_f32_dpp v20, v28, v28 row_ror:8 row_mask:0xf bank_mask:0xc
    v_add_f32_dpp v21, v29, v29 row_ror:8 row_mask:0xf bank_mask:0xc
    v_add_f32_dpp v22, v30, v30 row_ror:8 row_mask:0xf bank_mask:0xc
    v_add_f32_dpp v23, v31, v31 row_ror:8 row_mask:0xf bank_mask:0xc
    v_add_f32_dpp v16, v16, v16 row_shl:4 row_mask:0xf bank_mask:0x5
    v_add_f32_dpp v17, v17, v17 row_shl:4 row_mask:0xf bank_mask:0x5
    v_add_f32_dpp v18, v18, v18 row_shl:4 row_mask:0xf bank_mask:0x5
    v_add_f32_dpp v19, v19, v19 row_shl:4 row_mask:0xf bank_mask:0x5
    v_add_f32_dpp v16, v20, v20 row_shr:4 row_mask:0xf bank_mask:0xa
    v_add_f32_dpp v17, v21, v21 row_shr:4 row_mask:0xf bank_mask:0xa
    v_add_f32_dpp v18, v22, v22 row_shr:4 row_mask:0xf bank_mask:0xa
    v_add_f32_dpp v19, v23, v23 row_shr:4 row_mask:0xf bank_mask:0xa
    v_cndmask_b32_e64 v2, v18, v16, s[60:61]
    v_cndmask_b32_e64 v16, v16, v18, s[60:61]
    v_cndmask_b32_e64 v3, v19, v17, s[60:61]
    v_cndmask_b32_e64 v17, v17, v19, s[60:61]
    v_add_f32_dpp v16, v2, v16 quad_perm:[2,3,0,1] row_mask:0xf bank_mask:0xf
    s_nop 0
    v_add_f32_dpp v17, v3, v17 quad_perm:[2,3,0,1] row_mask:0xf bank_mask:0xf
    v_cndmask_b32_e64 v2, v17, v16, s[62:63]
    v_cndmask_b32_e64 v16, v16, v17, s[62:63]
    s_nop 1
    v_add_f32_dpp v16, v2, v16 quad_perm:[1,0,3,2] row_mask:0xf bank_mask:0xf
    v_mov_b32 v15, v16
    s_waitcnt vmcnt(2)
    buffer_load_dwordx4 v[140:143], v1, s[44:47], s50 offen offset:3072 nt
    s_add_u32 s50, s50, 0x8000
    s_sub_u32 s51, s51, 1
    s_cmp_lg_u32 s51, 0
    s_cbranch_scc1 KLOOP
    s_waitcnt vmcnt(2)
    buffer_load_dwordx4 v[144:147], v1, s[44:47], s50 offen offset:0 nt
    v_cvt_pk_bf16_f32 v2, v8, v9
    v_lshlrev_b32 v8, 16, v2
    v_and_b32 v9, 0xffff0000, v2
    v_cvt_pk_bf16_f32 v2, v10, v11
    v_lshlrev_b32 v10, 16, v2
    v_and_b32 v11, 0xffff0000, v2
    v_cvt_pk_bf16_f32 v2, v12, v13
    v_lshlrev_b32 v12, 16, v2
    v_and_b32 v13, 0xffff0000, v2
    v_cvt_pk_bf16_f32 v2, v14, v15
    v_lshlrev_b32 v14, 16, v2
    v_and_b32 v15, 0xffff0000, v2
    v_mul_f32 v8, 0x3db504f3, v8
    v_mul_f32 v9, 0x3db504f3, v9
    v_mul_f32 v10, 0x3db504f3, v10
    v_mul_f32 v11, 0x3db504f3, v11
    v_mul_f32 v12, 0x3db504f3, v12
    v_mul_f32 v13, 0x3db504f3, v13
    v_mul_f32 v14, 0x3db504f3, v14
    v_mul_f32 v15, 0x3db504f3, v15
    v_cvt_pk_bf16_f32 v2, v8, v9
    v_lshlrev_b32 v8, 16, v2
    v_and_b32 v9, 0xffff0000, v2
    v_cvt_pk_bf16_f32 v2, v10, v11
    v_lshlrev_b32 v10, 16, v2
    v_and_b32 v11, 0xffff0000, v2
    v_cvt_pk_bf16_f32 v2, v12, v13
    v_lshlrev_b32 v12, 16, v2
    v_and_b32 v13, 0xffff0000, v2
    v_cvt_pk_bf16_f32 v2, v14, v15
    v_lshlrev_b32 v14, 16, v2
    v_and_b32 v15, 0xffff0000, v2
    v_max3_f32 v16, v8, v9, v10
    v_max3_f32 v16, v16, v11, v12
    v_max3_f32 v16, v16, v13, v14
    v_max_f32 v16, v16, v15
    s_nop 1
    v_max_f32_dpp v16, v16, v16 row_ror:8 row_mask:0xf bank_mask:0xf
    s_nop 1
    v_max_f32_dpp v16, v16, v16 row_ror:4 row_mask:0xf bank_mask:0xf
    s_nop 1
    v_max_f32_dpp v16, v16, v16 row_ror:2 row_mask:0xf bank_mask:0xf
    s_nop 1
    v_max_f32_dpp v16, v16, v16 row_ror:1 row_mask:0xf bank_mask:0xf
    v_mov_b32 v2, v16
    s_nop 1
    v_permlane16_swap_b32 v16, v2
    v_max_f32 v16, v16, v2
    v_mov_b32 v2, v16
    s_nop 1
    v_permlane32_swap_b32 v16, v2
    v_max_f32 v16, v16, v2
    s_waitcnt vmcnt(2)
    buffer_load_dwordx4 v[148:151], v1, s[44:47], s50 offen offset:1024 nt
    v_sub_f32 v18, v8, v16
    v_mul_f32 v18, s74, v18
    v_exp_f32 v18, v18
    v_sub_f32 v19, v9, v16
    v_mul_f32 v19, s74, v19
    v_exp_f32 v19, v19
    v_sub_f32 v20, v10, v16
    v_mul_f32 v20, s74, v20
    v_exp_f32 v20, v20
    v_sub_f32 v21, v11, v16
    v_mul_f32 v21, s74, v21
    v_exp_f32 v21, v21
    v_sub_f32 v22, v12, v16
    v_mul_f32 v22, s74, v22
    v_exp_f32 v22, v22
    v_sub_f32 v23, v13, v16
    v_mul_f32 v23, s74, v23
    v_exp_f32 v23, v23
    v_sub_f32 v24, v14, v16
    v_mul_f32 v24, s74, v24
    v_exp_f32 v24, v24
    v_sub_f32 v25, v15, v16
    v_mul_f32 v25, s74, v25
    v_exp_f32 v25, v25
    v_add_f32 v17, v18, v19
    v_add_f32 v17, v17, v20
    v_add_f32 v17, v17, v21
    v_add_f32 v17, v17, v22
    v_add_f32 v17, v17, v23
    v_add_f32 v17, v17, v24
    v_add_f32 v17, v17, v25
    v_cvt_pk_bf16_f32 v8, v18, v18
    v_cvt_pk_bf16_f32 v9, v19, v19
    v_cvt_pk_bf16_f32 v10, v20, v20
    v_cvt_pk_bf16_f32 v11, v21, v21
    v_cvt_pk_bf16_f32 v12, v22, v22
    v_cvt_pk_bf16_f32 v13, v23, v23
    v_cvt_pk_bf16_f32 v14, v24, v24
    v_cvt_pk_bf16_f32 v15, v25, v25
    s_waitcnt vmcnt(2)
    buffer_load_dwordx4 v[152:155], v1, s[44:47], s50 offen offset:2048 nt
    v_add_f32_dpp v17, v17, v17 row_ror:8 row_mask:0xf bank_mask:0xf
    s_nop 1
    v_add_f32_dpp v17, v17, v17 row_ror:4 row_mask:0xf bank_mask:0xf
    s_nop 1
    v_add_f32_dpp v17, v17, v17 row_ror:2 row_mask:0xf bank_mask:0xf
    s_nop 1
    v_add_f32_dpp v17, v17, v17 row_ror:1 row_mask:0xf bank_mask:0xf
    v_mov_b32 v2, v17
    s_nop 1
    v_permlane16_swap_b32 v17, v2
    v_add_f32 v17, v17, v2
    v_mov_b32 v2, v17
    s_nop 1
    v_permlane32_swap_b32 v17, v2
    v_add_f32 v17, v17, v2
    s_waitcnt vmcnt(2)
    buffer_load_dwordx4 v[156:159], v1, s[44:47], s50 offen offset:3072 nt
    s_add_u32 s50, s50, 0x8000
    s_lshl_b32 s8, s3, 3
    s_add_u32 s8, s8, 114944
    v_mov_b32 v2, s8
    v_mov_b32 v3, 114688
    v_mov_b32 v18, 1
    s_mov_b64 exec, 1
    ds_write_b64 v2, v[16:17]
    s_waitcnt lgkmcnt(0)
    ds_add_u32 v3, v18 offset:8
    s_mov_b64 exec, -1
    v_mov_b32 v160, 0
    v_mov_b32 v161, 0
    v_mov_b32 v162, 0
    v_mov_b32 v163, 0
    s_mov_b32 s51, 3
VLOOP:
    v_and_b32_dpp v16, v8, v164 row_newbcast:0 row_mask:0xf bank_mask:0xf
    v_and_b32_dpp v17, v8, v165 row_newbcast:0 row_mask:0xf bank_mask:0xf
    v_and_b32_dpp v18, v8, v166 row_newbcast:0 row_mask:0xf bank_mask:0xf
    v_and_b32_dpp v19, v8, v167 row_newbcast:0 row_mask:0xf bank_mask:0xf
    s_nop 1
    v_mfma_f32_16x16x32_bf16 v[160:163], v[32:35], v[16:19], v[160:163]
    s_waitcnt vmcnt(2)
    buffer_load_dwordx4 v[32:35], v1, s[44:47], s50 offen offset:0 nt
    v_and_b32_dpp v20, v8, v164 row_newbcast:1 row_mask:0xf bank_mask:0xf
    v_and_b32_dpp v21, v8, v165 row_newbcast:1 row_mask:0xf bank_mask:0xf
    v_and_b32_dpp v22, v8, v166 row_newbcast:1 row_mask:0xf bank_mask:0xf
    v_and_b32_dpp v23, v8, v167 row_newbcast:1 row_mask:0xf bank_mask:0xf
    s_nop 1
    v_mfma_f32_16x16x32_bf16 v[160:163], v[36:39], v[20:23], v[160:163]
    s_waitcnt vmcnt(2)
    buffer_load_dwordx4 v[36:39], v1, s[44:47], s50 offen offset:1024 nt
    v_and_b32_dpp v16, v8, v164 row_newbcast:2 row_mask:0xf bank_mask:0xf
    v_and_b32_dpp v17, v8, v165 row_newbcast:2 row_mask:0xf bank_mask:0xf
    v_and_b32_dpp v18, v8, v166 row_newbcast:2 row_mask:0xf bank_mask:0xf
    v_and_b32_dpp v19, v8, v167 row_newbcast:2 row_mask:0xf bank_mask:0xf
    s_nop 1
    v_mfma_f32_16x16x32_bf16 v[160:163], v[40:43], v[16:19], v[160:163]
    s_waitcnt vmcnt(2)
    buffer_load_dwordx4 v[40:43], v1, s[44:47], s50 offen offset:2048 nt
    v_and_b32_dpp v20, v8, v164 row_newbcast:3 row_mask:0xf bank_mask:0xf
    v_and_b32_dpp v21, v8, v165 row_newbcast:3 row_mask:0xf bank_mask:0xf
    v_and_b32_dpp v22, v8, v166 row_newbcast:3 row_mask:0xf bank_mask:0xf
    v_and_b32_dpp v23, v8, v167 row_newbcast:3 row_mask:0xf bank_mask:0xf
    s_nop 1
    v_mfma_f32_16x16x32_bf16 v[160:163], v[44:47], v[20:23], v[160:163]
    s_waitcnt vmcnt(2)
    buffer_load_dwordx4 v[44:47], v1, s[44:47], s50 offen offset:3072 nt
    s_add_u32 s50, s50, 0x8000
    v_and_b32_dpp v16, v8, v164 row_newbcast:4 row_mask:0xf bank_mask:0xf
    v_and_b32_dpp v17, v8, v165 row_newbcast:4 row_mask:0xf bank_mask:0xf
    v_and_b32_dpp v18, v8, v166 row_newbcast:4 row_mask:0xf bank_mask:0xf
    v_and_b32_dpp v19, v8, v167 row_newbcast:4 row_mask:0xf bank_mask:0xf
    s_nop 1
    v_mfma_f32_16x16x32_bf16 v[160:163], v[48:51], v[16:19], v[160:163]
    s_waitcnt vmcnt(2)
    buffer_load_dwordx4 v[48:51], v1, s[44:47], s50 offen offset:0 nt
    v_and_b32_dpp v20, v8, v164 row_newbcast:5 row_mask:0xf bank_mask:0xf
    v_and_b32_dpp v21, v8, v165 row_newbcast:5 row_mask:0xf bank_mask:0xf
    v_and_b32_dpp v22, v8, v166 row_newbcast:5 row_mask:0xf bank_mask:0xf
    v_and_b32_dpp v23, v8, v167 row_newbcast:5 row_mask:0xf bank_mask:0xf
    s_nop 1
    v_mfma_f32_16x16x32_bf16 v[160:163], v[52:55], v[20:23], v[160:163]
    s_waitcnt vmcnt(2)
    buffer_load_dwordx4 v[52:55], v1, s[44:47], s50 offen offset:1024 nt
    v_and_b32_dpp v16, v8, v164 row_newbcast:6 row_mask:0xf bank_mask:0xf
    v_and_b32_dpp v17, v8, v165 row_newbcast:6 row_mask:0xf bank_mask:0xf
    v_and_b32_dpp v18, v8, v166 row_newbcast:6 row_mask:0xf bank_mask:0xf
    v_and_b32_dpp v19, v8, v167 row_newbcast:6 row_mask:0xf bank_mask:0xf
    s_nop 1
    v_mfma_f32_16x16x32_bf16 v[160:163], v[56:59], v[16:19], v[160:163]
    s_waitcnt vmcnt(2)
    buffer_load_dwordx4 v[56:59], v1, s[44:47], s50 offen offset:2048 nt
    v_and_b32_dpp v20, v8, v164 row_newbcast:7 row_mask:0xf bank_mask:0xf
    v_and_b32_dpp v21, v8, v165 row_newbcast:7 row_mask:0xf bank_mask:0xf
    v_and_b32_dpp v22, v8, v166 row_newbcast:7 row_mask:0xf bank_mask:0xf
    v_and_b32_dpp v23, v8, v167 row_newbcast:7 row_mask:0xf bank_mask:0xf
    s_nop 1
    v_mfma_f32_16x16x32_bf16 v[160:163], v[60:63], v[20:23], v[160:163]
    s_waitcnt vmcnt(2)
    buffer_load_dwordx4 v[60:63], v1, s[44:47], s50 offen offset:3072 nt
    s_add_u32 s50, s50, 0x8000
    v_and_b32_dpp v16, v8, v164 row_newbcast:8 row_mask:0xf bank_mask:0xf
    v_and_b32_dpp v17, v8, v165 row_newbcast:8 row_mask:0xf bank_mask:0xf
    v_and_b32_dpp v18, v8, v166 row_newbcast:8 row_mask:0xf bank_mask:0xf
    v_and_b32_dpp v19, v8, v167 row_newbcast:8 row_mask:0xf bank_mask:0xf
    s_nop 1
    v_mfma_f32_16x16x32_bf16 v[160:163], v[64:67], v[16:19], v[160:163]
    s_waitcnt vmcnt(2)
    buffer_load_dwordx4 v[64:67], v1, s[44:47], s50 offen offset:0 nt
    v_and_b32_dpp v20, v8, v164 row_newbcast:9 row_mask:0xf bank_mask:0xf
    v_and_b32_dpp v21, v8, v165 row_newbcast:9 row_mask:0xf bank_mask:0xf
    v_and_b32_dpp v22, v8, v166 row_newbcast:9 row_mask:0xf bank_mask:0xf
    v_and_b32_dpp v23, v8, v167 row_newbcast:9 row_mask:0xf bank_mask:0xf
    s_nop 1
    v_mfma_f32_16x16x32_bf16 v[160:163], v[68:71], v[20:23], v[160:163]
    s_waitcnt vmcnt(2)
    buffer_load_dwordx4 v[68:71], v1, s[44:47], s50 offen offset:1024 nt
    v_and_b32_dpp v16, v8, v164 row_newbcast:10 row_mask:0xf bank_mask:0xf
    v_and_b32_dpp v17, v8, v165 row_newbcast:10 row_mask:0xf bank_mask:0xf
    v_and_b32_dpp v18, v8, v166 row_newbcast:10 row_mask:0xf bank_mask:0xf
    v_and_b32_dpp v19, v8, v167 row_newbcast:10 row_mask:0xf bank_mask:0xf
    s_nop 1
    v_mfma_f32_16x16x32_bf16 v[160:163], v[72:75], v[16:19], v[160:163]
    s_waitcnt vmcnt(2)
    buffer_load_dwordx4 v[72:75], v1, s[44:47], s50 offen offset:2048 nt
    v_and_b32_dpp v20, v8, v164 row_newbcast:11 row_mask:0xf bank_mask:0xf
    v_and_b32_dpp v21, v8, v165 row_newbcast:11 row_mask:0xf bank_mask:0xf
    v_and_b32_dpp v22, v8, v166 row_newbcast:11 row_mask:0xf bank_mask:0xf
    v_and_b32_dpp v23, v8, v167 row_newbcast:11 row_mask:0xf bank_mask:0xf
    s_nop 1
    v_mfma_f32_16x16x32_bf16 v[160:163], v[76:79], v[20:23], v[160:163]
    s_waitcnt vmcnt(2)
    buffer_load_dwordx4 v[76:79], v1, s[44:47], s50 offen offset:3072 nt
    s_add_u32 s50, s50, 0x8000
    v_and_b32_dpp v16, v8, v164 row_newbcast:12 row_mask:0xf bank_mask:0xf
    v_and_b32_dpp v17, v8, v165 row_newbcast:12 row_mask:0xf bank_mask:0xf
    v_and_b32_dpp v18, v8, v166 row_newbcast:12 row_mask:0xf bank_mask:0xf
    v_and_b32_dpp v19, v8, v167 row_newbcast:12 row_mask:0xf bank_mask:0xf
    s_nop 1
    v_mfma_f32_16x16x32_bf16 v[160:163], v[80:83], v[16:19], v[160:163]
    s_waitcnt vmcnt(2)
    buffer_load_dwordx4 v[80:83], v1, s[44:47], s50 offen offset:0 nt
    v_and_b32_dpp v20, v8, v164 row_newbcast:13 row_mask:0xf bank_mask:0xf
    v_and_b32_dpp v21, v8, v165 row_newbcast:13 row_mask:0xf bank_mask:0xf
    v_and_b32_dpp v22, v8, v166 row_newbcast:13 row_mask:0xf bank_mask:0xf
    v_and_b32_dpp v23, v8, v167 row_newbcast:13 row_mask:0xf bank_mask:0xf
    s_nop 1
    v_mfma_f32_16x16x32_bf16 v[160:163], v[84:87], v[20:23], v[160:163]
    s_waitcnt vmcnt(2)
    buffer_load_dwordx4 v[84:87], v1, s[44:47], s50 offen offset:1024 nt
    v_and_b32_dpp v16, v8, v164 row_newbcast:14 row_mask:0xf bank_mask:0xf
    v_and_b32_dpp v17, v8, v165 row_newbcast:14 row_mask:0xf bank_mask:0xf
    v_and_b32_dpp v18, v8, v166 row_newbcast:14 row_mask:0xf bank_mask:0xf
    v_and_b32_dpp v19, v8, v167 row_newbcast:14 row_mask:0xf bank_mask:0xf
    s_nop 1
    v_mfma_f32_16x16x32_bf16 v[160:163], v[88:91], v[16:19], v[160:163]
    s_waitcnt vmcnt(2)
    buffer_load_dwordx4 v[88:91], v1, s[44:47], s50 offen offset:2048 nt
    v_and_b32_dpp v20, v8, v164 row_newbcast:15 row_mask:0xf bank_mask:0xf
    v_and_b32_dpp v21, v8, v165 row_newbcast:15 row_mask:0xf bank_mask:0xf
    v_and_b32_dpp v22, v8, v166 row_newbcast:15 row_mask:0xf bank_mask:0xf
    v_and_b32_dpp v23, v8, v167 row_newbcast:15 row_mask:0xf bank_mask:0xf
    s_nop 1
    v_mfma_f32_16x16x32_bf16 v[160:163], v[92:95], v[20:23], v[160:163]
    s_waitcnt vmcnt(2)
    buffer_load_dwordx4 v[92:95], v1, s[44:47], s50 offen offset:3072 nt
    s_add_u32 s50, s50, 0x8000
    v_and_b32_dpp v16, v9, v164 row_newbcast:0 row_mask:0xf bank_mask:0xf
    v_and_b32_dpp v17, v9, v165 row_newbcast:0 row_mask:0xf bank_mask:0xf
    v_and_b32_dpp v18, v9, v166 row_newbcast:0 row_mask:0xf bank_mask:0xf
    v_and_b32_dpp v19, v9, v167 row_newbcast:0 row_mask:0xf bank_mask:0xf
    s_nop 1
    v_mfma_f32_16x16x32_bf16 v[160:163], v[96:99], v[16:19], v[160:163]
    s_waitcnt vmcnt(2)
    buffer_load_dwordx4 v[96:99], v1, s[44:47], s50 offen offset:0 nt
    v_and_b32_dpp v20, v9, v164 row_newbcast:1 row_mask:0xf bank_mask:0xf
    v_and_b32_dpp v21, v9, v165 row_newbcast:1 row_mask:0xf bank_mask:0xf
    v_and_b32_dpp v22, v9, v166 row_newbcast:1 row_mask:0xf bank_mask:0xf
    v_and_b32_dpp v23, v9, v167 row_newbcast:1 row_mask:0xf bank_mask:0xf
    s_nop 1
    v_mfma_f32_16x16x32_bf16 v[160:163], v[100:103], v[20:23], v[160:163]
    s_waitcnt vmcnt(2)
    buffer_load_dwordx4 v[100:103], v1, s[44:47], s50 offen offset:1024 nt
    v_and_b32_dpp v16, v9, v164 row_newbcast:2 row_mask:0xf bank_mask:0xf
    v_and_b32_dpp v17, v9, v165 row_newbcast:2 row_mask:0xf bank_mask:0xf
    v_and_b32_dpp v18, v9, v166 row_newbcast:2 row_mask:0xf bank_mask:0xf
    v_and_b32_dpp v19, v9, v167 row_newbcast:2 row_mask:0xf bank_mask:0xf
    s_nop 1
    v_mfma_f32_16x16x32_bf16 v[160:163], v[104:107], v[16:19], v[160:163]
    s_waitcnt vmcnt(2)
    buffer_load_dwordx4 v[104:107], v1, s[44:47], s50 offen offset:2048 nt
    v_and_b32_dpp v20, v9, v164 row_newbcast:3 row_mask:0xf bank_mask:0xf
    v_and_b32_dpp v21, v9, v165 row_newbcast:3 row_mask:0xf bank_mask:0xf
    v_and_b32_dpp v22, v9, v166 row_newbcast:3 row_mask:0xf bank_mask:0xf
    v_and_b32_dpp v23, v9, v167 row_newbcast:3 row_mask:0xf bank_mask:0xf
    s_nop 1
    v_mfma_f32_16x16x32_bf16 v[160:163], v[108:111], v[20:23], v[160:163]
    s_waitcnt vmcnt(2)
    buffer_load_dwordx4 v[108:111], v1, s[44:47], s50 offen offset:3072 nt
    s_add_u32 s50, s50, 0x8000
    v_and_b32_dpp v16, v9, v164 row_newbcast:4 row_mask:0xf bank_mask:0xf
    v_and_b32_dpp v17, v9, v165 row_newbcast:4 row_mask:0xf bank_mask:0xf
    v_and_b32_dpp v18, v9, v166 row_newbcast:4 row_mask:0xf bank_mask:0xf
    v_and_b32_dpp v19, v9, v167 row_newbcast:4 row_mask:0xf bank_mask:0xf
    s_nop 1
    v_mfma_f32_16x16x32_bf16 v[160:163], v[112:115], v[16:19], v[160:163]
    s_waitcnt vmcnt(2)
    buffer_load_dwordx4 v[112:115], v1, s[44:47], s50 offen offset:0 nt
    v_and_b32_dpp v20, v9, v164 row_newbcast:5 row_mask:0xf bank_mask:0xf
    v_and_b32_dpp v21, v9, v165 row_newbcast:5 row_mask:0xf bank_mask:0xf
    v_and_b32_dpp v22, v9, v166 row_newbcast:5 row_mask:0xf bank_mask:0xf
    v_and_b32_dpp v23, v9, v167 row_newbcast:5 row_mask:0xf bank_mask:0xf
    s_nop 1
    v_mfma_f32_16x16x32_bf16 v[160:163], v[116:119], v[20:23], v[160:163]
    s_waitcnt vmcnt(2)
    buffer_load_dwordx4 v[116:119], v1, s[44:47], s50 offen offset:1024 nt
    v_and_b32_dpp v16, v9, v164 row_newbcast:6 row_mask:0xf bank_mask:0xf
    v_and_b32_dpp v17, v9, v165 row_newbcast:6 row_mask:0xf bank_mask:0xf
    v_and_b32_dpp v18, v9, v166 row_newbcast:6 row_mask:0xf bank_mask:0xf
    v_and_b32_dpp v19, v9, v167 row_newbcast:6 row_mask:0xf bank_mask:0xf
    s_nop 1
    v_mfma_f32_16x16x32_bf16 v[160:163], v[120:123], v[16:19], v[160:163]
    s_waitcnt vmcnt(2)
    buffer_load_dwordx4 v[120:123], v1, s[44:47], s50 offen offset:2048 nt
    v_and_b32_dpp v20, v9, v164 row_newbcast:7 row_mask:0xf bank_mask:0xf
    v_and_b32_dpp v21, v9, v165 row_newbcast:7 row_mask:0xf bank_mask:0xf
    v_and_b32_dpp v22, v9, v166 row_newbcast:7 row_mask:0xf bank_mask:0xf
    v_and_b32_dpp v23, v9, v167 row_newbcast:7 row_mask:0xf bank_mask:0xf
    s_nop 1
    v_mfma_f32_16x16x32_bf16 v[160:163], v[124:127], v[20:23], v[160:163]
    s_waitcnt vmcnt(2)
    buffer_load_dwordx4 v[124:127], v1, s[44:47], s50 offen offset:3072 nt
    s_add_u32 s50, s50, 0x8000
    v_and_b32_dpp v16, v9, v164 row_newbcast:8 row_mask:0xf bank_mask:0xf
    v_and_b32_dpp v17, v9, v165 row_newbcast:8 row_mask:0xf bank_mask:0xf
    v_and_b32_dpp v18, v9, v166 row_newbcast:8 row_mask:0xf bank_mask:0xf
    v_and_b32_dpp v19, v9, v167 row_newbcast:8 row_mask:0xf bank_mask:0xf
    s_nop 1
    v_mfma_f32_16x16x32_bf16 v[160:163], v[128:131], v[16:19], v[160:163]
    s_waitcnt vmcnt(2)
    buffer_load_dwordx4 v[128:131], v1, s[44:47], s50 offen offset:0 nt
    v_and_b32_dpp v20, v9, v164 row_newbcast:9 row_mask:0xf bank_mask:0xf
    v_and_b32_dpp v21, v9, v165 row_newbcast:9 row_mask:0xf bank_mask:0xf
    v_and_b32_dpp v22, v9, v166 row_newbcast:9 row_mask:0xf bank_mask:0xf
    v_and_b32_dpp v23, v9, v167 row_newbcast:9 row_mask:0xf bank_mask:0xf
    s_nop 1
    v_mfma_f32_16x16x32_bf16 v[160:163], v[132:135], v[20:23], v[160:163]
    s_waitcnt vmcnt(2)
    buffer_load_dwordx4 v[132:135], v1, s[44:47], s50 offen offset:1024 nt
    v_and_b32_dpp v16, v9, v164 row_newbcast:10 row_mask:0xf bank_mask:0xf
    v_and_b32_dpp v17, v9, v165 row_newbcast:10 row_mask:0xf bank_mask:0xf
    v_and_b32_dpp v18, v9, v166 row_newbcast:10 row_mask:0xf bank_mask:0xf
    v_and_b32_dpp v19, v9, v167 row_newbcast:10 row_mask:0xf bank_mask:0xf
    s_nop 1
    v_mfma_f32_16x16x32_bf16 v[160:163], v[136:139], v[16:19], v[160:163]
    s_waitcnt vmcnt(2)
    buffer_load_dwordx4 v[136:139], v1, s[44:47], s50 offen offset:2048 nt
    v_and_b32_dpp v20, v9, v164 row_newbcast:11 row_mask:0xf bank_mask:0xf
    v_and_b32_dpp v21, v9, v165 row_newbcast:11 row_mask:0xf bank_mask:0xf
    v_and_b32_dpp v22, v9, v166 row_newbcast:11 row_mask:0xf bank_mask:0xf
    v_and_b32_dpp v23, v9, v167 row_newbcast:11 row_mask:0xf bank_mask:0xf
    s_nop 1
    v_mfma_f32_16x16x32_bf16 v[160:163], v[140:143], v[20:23], v[160:163]
    s_waitcnt vmcnt(2)
    buffer_load_dwordx4 v[140:143], v1, s[44:47], s50 offen offset:3072 nt
    s_add_u32 s50, s50, 0x8000
    v_and_b32_dpp v16, v9, v164 row_newbcast:12 row_mask:0xf bank_mask:0xf
    v_and_b32_dpp v17, v9, v165 row_newbcast:12 row_mask:0xf bank_mask:0xf
    v_and_b32_dpp v18, v9, v166 row_newbcast:12 row_mask:0xf bank_mask:0xf
    v_and_b32_dpp v19, v9, v167 row_newbcast:12 row_mask:0xf bank_mask:0xf
    s_nop 1
    v_mfma_f32_16x16x32_bf16 v[160:163], v[144:147], v[16:19], v[160:163]
    s_waitcnt vmcnt(2)
    buffer_load_dwordx4 v[144:147], v1, s[44:47], s50 offen offset:0 nt
    v_and_b32_dpp v20, v9, v164 row_newbcast:13 row_mask:0xf bank_mask:0xf
    v_and_b32_dpp v21, v9, v165 row_newbcast:13 row_mask:0xf bank_mask:0xf
    v_and_b32_dpp v22, v9, v166 row_newbcast:13 row_mask:0xf bank_mask:0xf
    v_and_b32_dpp v23, v9, v167 row_newbcast:13 row_mask:0xf bank_mask:0xf
    s_nop 1
    v_mfma_f32_16x16x32_bf16 v[160:163], v[148:151], v[20:23], v[160:163]
    s_waitcnt vmcnt(2)
    buffer_load_dwordx4 v[148:151], v1, s[44:47], s50 offen offset:1024 nt
    v_and_b32_dpp v16, v9, v164 row_newbcast:14 row_mask:0xf bank_mask:0xf
    v_and_b32_dpp v17, v9, v165 row_newbcast:14 row_mask:0xf bank_mask:0xf
    v_and_b32_dpp v18, v9, v166 row_newbcast:14 row_mask:0xf bank_mask:0xf
    v_and_b32_dpp v19, v9, v167 row_newbcast:14 row_mask:0xf bank_mask:0xf
    s_nop 1
    v_mfma_f32_16x16x32_bf16 v[160:163], v[152:155], v[16:19], v[160:163]
    s_waitcnt vmcnt(2)
    buffer_load_dwordx4 v[152:155], v1, s[44:47], s50 offen offset:2048 nt
    v_and_b32_dpp v20, v9, v164 row_newbcast:15 row_mask:0xf bank_mask:0xf
    v_and_b32_dpp v21, v9, v165 row_newbcast:15 row_mask:0xf bank_mask:0xf
    v_and_b32_dpp v22, v9, v166 row_newbcast:15 row_mask:0xf bank_mask:0xf
    v_and_b32_dpp v23, v9, v167 row_newbcast:15 row_mask:0xf bank_mask:0xf
    s_nop 1
    v_mfma_f32_16x16x32_bf16 v[160:163], v[156:159], v[20:23], v[160:163]
    s_waitcnt vmcnt(2)
    buffer_load_dwordx4 v[156:159], v1, s[44:47], s50 offen offset:3072 nt
    s_add_u32 s50, s50, 0x8000
    v_mov_b32 v8, v10
    v_mov_b32 v9, v11
    v_mov_b32 v10, v12
    v_mov_b32 v11, v13
    v_mov_b32 v12, v14
    v_mov_b32 v13, v15
    s_sub_u32 s51, s51, 1
    s_cmp_lg_u32 s51, 0
    s_cbranch_scc1 VLOOP
    v_and_b32_dpp v16, v8, v164 row_newbcast:0 row_mask:0xf bank_mask:0xf
    v_and_b32_dpp v17, v8, v165 row_newbcast:0 row_mask:0xf bank_mask:0xf
    v_and_b32_dpp v18, v8, v166 row_newbcast:0 row_mask:0xf bank_mask:0xf
    v_and_b32_dpp v19, v8, v167 row_newbcast:0 row_mask:0xf bank_mask:0xf
    s_nop 1
    v_mfma_f32_16x16x32_bf16 v[160:163], v[32:35], v[16:19], v[160:163]
    v_and_b32_dpp v20, v8, v164 row_newbcast:1 row_mask:0xf bank_mask:0xf
    v_and_b32_dpp v21, v8, v165 row_newbcast:1 row_mask:0xf bank_mask:0xf
    v_and_b32_dpp v22, v8, v166 row_newbcast:1 row_mask:0xf bank_mask:0xf
    v_and_b32_dpp v23, v8, v167 row_newbcast:1 row_mask:0xf bank_mask:0xf
    s_nop 1
    v_mfma_f32_16x16x32_bf16 v[160:163], v[36:39], v[20:23], v[160:163]
    v_and_b32_dpp v16, v8, v164 row_newbcast:2 row_mask:0xf bank_mask:0xf
    v_and_b32_dpp v17, v8, v165 row_newbcast:2 row_mask:0xf bank_mask:0xf
    v_and_b32_dpp v18, v8, v166 row_newbcast:2 row_mask:0xf bank_mask:0xf
    v_and_b32_dpp v19, v8, v167 row_newbcast:2 row_mask:0xf bank_mask:0xf
    s_nop 1
    v_mfma_f32_16x16x32_bf16 v[160:163], v[40:43], v[16:19], v[160:163]
    v_and_b32_dpp v20, v8, v164 row_newbcast:3 row_mask:0xf bank_mask:0xf
    v_and_b32_dpp v21, v8, v165 row_newbcast:3 row_mask:0xf bank_mask:0xf
    v_and_b32_dpp v22, v8, v166 row_newbcast:3 row_mask:0xf bank_mask:0xf
    v_and_b32_dpp v23, v8, v167 row_newbcast:3 row_mask:0xf bank_mask:0xf
    s_nop 1
    v_mfma_f32_16x16x32_bf16 v[160:163], v[44:47], v[20:23], v[160:163]
    v_and_b32_dpp v16, v8, v164 row_newbcast:4 row_mask:0xf bank_mask:0xf
    v_and_b32_dpp v17, v8, v165 row_newbcast:4 row_mask:0xf bank_mask:0xf
    v_and_b32_dpp v18, v8, v166 row_newbcast:4 row_mask:0xf bank_mask:0xf
    v_and_b32_dpp v19, v8, v167 row_newbcast:4 row_mask:0xf bank_mask:0xf
    s_nop 1
    v_mfma_f32_16x16x32_bf16 v[160:163], v[48:51], v[16:19], v[160:163]
    v_and_b32_dpp v20, v8, v164 row_newbcast:5 row_mask:0xf bank_mask:0xf
    v_and_b32_dpp v21, v8, v165 row_newbcast:5 row_mask:0xf bank_mask:0xf
    v_and_b32_dpp v22, v8, v166 row_newbcast:5 row_mask:0xf bank_mask:0xf
    v_and_b32_dpp v23, v8, v167 row_newbcast:5 row_mask:0xf bank_mask:0xf
    s_nop 1
    v_mfma_f32_16x16x32_bf16 v[160:163], v[52:55], v[20:23], v[160:163]
    v_and_b32_dpp v16, v8, v164 row_newbcast:6 row_mask:0xf bank_mask:0xf
    v_and_b32_dpp v17, v8, v165 row_newbcast:6 row_mask:0xf bank_mask:0xf
    v_and_b32_dpp v18, v8, v166 row_newbcast:6 row_mask:0xf bank_mask:0xf
    v_and_b32_dpp v19, v8, v167 row_newbcast:6 row_mask:0xf bank_mask:0xf
    s_nop 1
    v_mfma_f32_16x16x32_bf16 v[160:163], v[56:59], v[16:19], v[160:163]
    v_and_b32_dpp v20, v8, v164 row_newbcast:7 row_mask:0xf bank_mask:0xf
    v_and_b32_dpp v21, v8, v165 row_newbcast:7 row_mask:0xf bank_mask:0xf
    v_and_b32_dpp v22, v8, v166 row_newbcast:7 row_mask:0xf bank_mask:0xf
    v_and_b32_dpp v23, v8, v167 row_newbcast:7 row_mask:0xf bank_mask:0xf
    s_nop 1
    v_mfma_f32_16x16x32_bf16 v[160:163], v[60:63], v[20:23], v[160:163]
    v_and_b32_dpp v16, v8, v164 row_newbcast:8 row_mask:0xf bank_mask:0xf
    v_and_b32_dpp v17, v8, v165 row_newbcast:8 row_mask:0xf bank_mask:0xf
    v_and_b32_dpp v18, v8, v166 row_newbcast:8 row_mask:0xf bank_mask:0xf
    v_and_b32_dpp v19, v8, v167 row_newbcast:8 row_mask:0xf bank_mask:0xf
    s_nop 1
    v_mfma_f32_16x16x32_bf16 v[160:163], v[64:67], v[16:19], v[160:163]
    v_and_b32_dpp v20, v8, v164 row_newbcast:9 row_mask:0xf bank_mask:0xf
    v_and_b32_dpp v21, v8, v165 row_newbcast:9 row_mask:0xf bank_mask:0xf
    v_and_b32_dpp v22, v8, v166 row_newbcast:9 row_mask:0xf bank_mask:0xf
    v_and_b32_dpp v23, v8, v167 row_newbcast:9 row_mask:0xf bank_mask:0xf
    s_nop 1
    v_mfma_f32_16x16x32_bf16 v[160:163], v[68:71], v[20:23], v[160:163]
    v_and_b32_dpp v16, v8, v164 row_newbcast:10 row_mask:0xf bank_mask:0xf
    v_and_b32_dpp v17, v8, v165 row_newbcast:10 row_mask:0xf bank_mask:0xf
    v_and_b32_dpp v18, v8, v166 row_newbcast:10 row_mask:0xf bank_mask:0xf
    v_and_b32_dpp v19, v8, v167 row_newbcast:10 row_mask:0xf bank_mask:0xf
    s_nop 1
    v_mfma_f32_16x16x32_bf16 v[160:163], v[72:75], v[16:19], v[160:163]
    v_and_b32_dpp v20, v8, v164 row_newbcast:11 row_mask:0xf bank_mask:0xf
    v_and_b32_dpp v21, v8, v165 row_newbcast:11 row_mask:0xf bank_mask:0xf
    v_and_b32_dpp v22, v8, v166 row_newbcast:11 row_mask:0xf bank_mask:0xf
    v_and_b32_dpp v23, v8, v167 row_newbcast:11 row_mask:0xf bank_mask:0xf
    s_nop 1
    v_mfma_f32_16x16x32_bf16 v[160:163], v[76:79], v[20:23], v[160:163]
    v_and_b32_dpp v16, v8, v164 row_newbcast:12 row_mask:0xf bank_mask:0xf
    v_and_b32_dpp v17, v8, v165 row_newbcast:12 row_mask:0xf bank_mask:0xf
    v_and_b32_dpp v18, v8, v166 row_newbcast:12 row_mask:0xf bank_mask:0xf
    v_and_b32_dpp v19, v8, v167 row_newbcast:12 row_mask:0xf bank_mask:0xf
    s_nop 1
    v_mfma_f32_16x16x32_bf16 v[160:163], v[80:83], v[16:19], v[160:163]
    v_and_b32_dpp v20, v8, v164 row_newbcast:13 row_mask:0xf bank_mask:0xf
    v_and_b32_dpp v21, v8, v165 row_newbcast:13 row_mask:0xf bank_mask:0xf
    v_and_b32_dpp v22, v8, v166 row_newbcast:13 row_mask:0xf bank_mask:0xf
    v_and_b32_dpp v23, v8, v167 row_newbcast:13 row_mask:0xf bank_mask:0xf
    s_nop 1
    v_mfma_f32_16x16x32_bf16 v[160:163], v[84:87], v[20:23], v[160:163]
    v_and_b32_dpp v16, v8, v164 row_newbcast:14 row_mask:0xf bank_mask:0xf
    v_and_b32_dpp v17, v8, v165 row_newbcast:14 row_mask:0xf bank_mask:0xf
    v_and_b32_dpp v18, v8, v166 row_newbcast:14 row_mask:0xf bank_mask:0xf
    v_and_b32_dpp v19, v8, v167 row_newbcast:14 row_mask:0xf bank_mask:0xf
    s_nop 1
    v_mfma_f32_16x16x32_bf16 v[160:163], v[88:91], v[16:19], v[160:163]
    v_and_b32_dpp v20, v8, v164 row_newbcast:15 row_mask:0xf bank_mask:0xf
    v_and_b32_dpp v21, v8, v165 row_newbcast:15 row_mask:0xf bank_mask:0xf
    v_and_b32_dpp v22, v8, v166 row_newbcast:15 row_mask:0xf bank_mask:0xf
    v_and_b32_dpp v23, v8, v167 row_newbcast:15 row_mask:0xf bank_mask:0xf
    s_nop 1
    v_mfma_f32_16x16x32_bf16 v[160:163], v[92:95], v[20:23], v[160:163]
    v_and_b32_dpp v16, v9, v164 row_newbcast:0 row_mask:0xf bank_mask:0xf
    v_and_b32_dpp v17, v9, v165 row_newbcast:0 row_mask:0xf bank_mask:0xf
    v_and_b32_dpp v18, v9, v166 row_newbcast:0 row_mask:0xf bank_mask:0xf
    v_and_b32_dpp v19, v9, v167 row_newbcast:0 row_mask:0xf bank_mask:0xf
    s_nop 1
    v_mfma_f32_16x16x32_bf16 v[160:163], v[96:99], v[16:19], v[160:163]
    v_and_b32_dpp v20, v9, v164 row_newbcast:1 row_mask:0xf bank_mask:0xf
    v_and_b32_dpp v21, v9, v165 row_newbcast:1 row_mask:0xf bank_mask:0xf
    v_and_b32_dpp v22, v9, v166 row_newbcast:1 row_mask:0xf bank_mask:0xf
    v_and_b32_dpp v23, v9, v167 row_newbcast:1 row_mask:0xf bank_mask:0xf
    s_nop 1
    v_mfma_f32_16x16x32_bf16 v[160:163], v[100:103], v[20:23], v[160:163]
    v_and_b32_dpp v16, v9, v164 row_newbcast:2 row_mask:0xf bank_mask:0xf
    v_and_b32_dpp v17, v9, v165 row_newbcast:2 row_mask:0xf bank_mask:0xf
    v_and_b32_dpp v18, v9, v166 row_newbcast:2 row_mask:0xf bank_mask:0xf
    v_and_b32_dpp v19, v9, v167 row_newbcast:2 row_mask:0xf bank_mask:0xf
    s_nop 1
    v_mfma_f32_16x16x32_bf16 v[160:163], v[104:107], v[16:19], v[160:163]
    v_and_b32_dpp v20, v9, v164 row_newbcast:3 row_mask:0xf bank_mask:0xf
    v_and_b32_dpp v21, v9, v165 row_newbcast:3 row_mask:0xf bank_mask:0xf
    v_and_b32_dpp v22, v9, v166 row_newbcast:3 row_mask:0xf bank_mask:0xf
    v_and_b32_dpp v23, v9, v167 row_newbcast:3 row_mask:0xf bank_mask:0xf
    s_nop 1
    v_mfma_f32_16x16x32_bf16 v[160:163], v[108:111], v[20:23], v[160:163]
    v_and_b32_dpp v16, v9, v164 row_newbcast:4 row_mask:0xf bank_mask:0xf
    v_and_b32_dpp v17, v9, v165 row_newbcast:4 row_mask:0xf bank_mask:0xf
    v_and_b32_dpp v18, v9, v166 row_newbcast:4 row_mask:0xf bank_mask:0xf
    v_and_b32_dpp v19, v9, v167 row_newbcast:4 row_mask:0xf bank_mask:0xf
    s_nop 1
    v_mfma_f32_16x16x32_bf16 v[160:163], v[112:115], v[16:19], v[160:163]
    v_and_b32_dpp v20, v9, v164 row_newbcast:5 row_mask:0xf bank_mask:0xf
    v_and_b32_dpp v21, v9, v165 row_newbcast:5 row_mask:0xf bank_mask:0xf
    v_and_b32_dpp v22, v9, v166 row_newbcast:5 row_mask:0xf bank_mask:0xf
    v_and_b32_dpp v23, v9, v167 row_newbcast:5 row_mask:0xf bank_mask:0xf
    s_nop 1
    v_mfma_f32_16x16x32_bf16 v[160:163], v[116:119], v[20:23], v[160:163]
    v_and_b32_dpp v16, v9, v164 row_newbcast:6 row_mask:0xf bank_mask:0xf
    v_and_b32_dpp v17, v9, v165 row_newbcast:6 row_mask:0xf bank_mask:0xf
    v_and_b32_dpp v18, v9, v166 row_newbcast:6 row_mask:0xf bank_mask:0xf
    v_and_b32_dpp v19, v9, v167 row_newbcast:6 row_mask:0xf bank_mask:0xf
    s_nop 1
    v_mfma_f32_16x16x32_bf16 v[160:163], v[120:123], v[16:19], v[160:163]
    v_and_b32_dpp v20, v9, v164 row_newbcast:7 row_mask:0xf bank_mask:0xf
    v_and_b32_dpp v21, v9, v165 row_newbcast:7 row_mask:0xf bank_mask:0xf
    v_and_b32_dpp v22, v9, v166 row_newbcast:7 row_mask:0xf bank_mask:0xf
    v_and_b32_dpp v23, v9, v167 row_newbcast:7 row_mask:0xf bank_mask:0xf
    s_nop 1
    v_mfma_f32_16x16x32_bf16 v[160:163], v[124:127], v[20:23], v[160:163]
    v_and_b32_dpp v16, v9, v164 row_newbcast:8 row_mask:0xf bank_mask:0xf
    v_and_b32_dpp v17, v9, v165 row_newbcast:8 row_mask:0xf bank_mask:0xf
    v_and_b32_dpp v18, v9, v166 row_newbcast:8 row_mask:0xf bank_mask:0xf
    v_and_b32_dpp v19, v9, v167 row_newbcast:8 row_mask:0xf bank_mask:0xf
    s_nop 1
    v_mfma_f32_16x16x32_bf16 v[160:163], v[128:131], v[16:19], v[160:163]
    v_and_b32_dpp v20, v9, v164 row_newbcast:9 row_mask:0xf bank_mask:0xf
    v_and_b32_dpp v21, v9, v165 row_newbcast:9 row_mask:0xf bank_mask:0xf
    v_and_b32_dpp v22, v9, v166 row_newbcast:9 row_mask:0xf bank_mask:0xf
    v_and_b32_dpp v23, v9, v167 row_newbcast:9 row_mask:0xf bank_mask:0xf
    s_nop 1
    v_mfma_f32_16x16x32_bf16 v[160:163], v[132:135], v[20:23], v[160:163]
    v_and_b32_dpp v16, v9, v164 row_newbcast:10 row_mask:0xf bank_mask:0xf
    v_and_b32_dpp v17, v9, v165 row_newbcast:10 row_mask:0xf bank_mask:0xf
    v_and_b32_dpp v18, v9, v166 row_newbcast:10 row_mask:0xf bank_mask:0xf
    v_and_b32_dpp v19, v9, v167 row_newbcast:10 row_mask:0xf bank_mask:0xf
    s_nop 1
    v_mfma_f32_16x16x32_bf16 v[160:163], v[136:139], v[16:19], v[160:163]
    v_and_b32_dpp v20, v9, v164 row_newbcast:11 row_mask:0xf bank_mask:0xf
    v_and_b32_dpp v21, v9, v165 row_newbcast:11 row_mask:0xf bank_mask:0xf
    v_and_b32_dpp v22, v9, v166 row_newbcast:11 row_mask:0xf bank_mask:0xf
    v_and_b32_dpp v23, v9, v167 row_newbcast:11 row_mask:0xf bank_mask:0xf
    s_nop 1
    v_mfma_f32_16x16x32_bf16 v[160:163], v[140:143], v[20:23], v[160:163]
    v_and_b32_dpp v16, v9, v164 row_newbcast:12 row_mask:0xf bank_mask:0xf
    v_and_b32_dpp v17, v9, v165 row_newbcast:12 row_mask:0xf bank_mask:0xf
    v_and_b32_dpp v18, v9, v166 row_newbcast:12 row_mask:0xf bank_mask:0xf
    v_and_b32_dpp v19, v9, v167 row_newbcast:12 row_mask:0xf bank_mask:0xf
    s_nop 1
    v_mfma_f32_16x16x32_bf16 v[160:163], v[144:147], v[16:19], v[160:163]
    s_waitcnt vmcnt(2)
    v_and_b32_dpp v20, v9, v164 row_newbcast:13 row_mask:0xf bank_mask:0xf
    v_and_b32_dpp v21, v9, v165 row_newbcast:13 row_mask:0xf bank_mask:0xf
    v_and_b32_dpp v22, v9, v166 row_newbcast:13 row_mask:0xf bank_mask:0xf
    v_and_b32_dpp v23, v9, v167 row_newbcast:13 row_mask:0xf bank_mask:0xf
    s_nop 1
    v_mfma_f32_16x16x32_bf16 v[160:163], v[148:151], v[20:23], v[160:163]
    s_waitcnt vmcnt(1)
    v_and_b32_dpp v16, v9, v164 row_newbcast:14 row_mask:0xf bank_mask:0xf
    v_and_b32_dpp v17, v9, v165 row_newbcast:14 row_mask:0xf bank_mask:0xf
    v_and_b32_dpp v18, v9, v166 row_newbcast:14 row_mask:0xf bank_mask:0xf
    v_and_b32_dpp v19, v9, v167 row_newbcast:14 row_mask:0xf bank_mask:0xf
    s_nop 1
    v_mfma_f32_16x16x32_bf16 v[160:163], v[152:155], v[16:19], v[160:163]
    s_waitcnt vmcnt(0)
    v_and_b32_dpp v20, v9, v164 row_newbcast:15 row_mask:0xf bank_mask:0xf
    v_and_b32_dpp v21, v9, v165 row_newbcast:15 row_mask:0xf bank_mask:0xf
    v_and_b32_dpp v22, v9, v166 row_newbcast:15 row_mask:0xf bank_mask:0xf
    v_and_b32_dpp v23, v9, v167 row_newbcast:15 row_mask:0xf bank_mask:0xf
    s_nop 1
    v_mfma_f32_16x16x32_bf16 v[160:163], v[156:159], v[20:23], v[160:163]
    s_lshl_b32 s8, s3, 9
    s_add_u32 s8, s8, 117248
    v_lshrrev_b32 v2, 4, v0
    v_lshlrev_b32 v2, 7, v2
    v_and_b32 v3, 15, v0
    v_lshl_add_u32 v2, v3, 2, v2
    v_add_u32 v2, s8, v2
    s_mov_b32 exec_lo, 0x00ff00ff
    s_mov_b32 exec_hi, 0x00ff00ff
    ds_write_b32 v2, v160 offset:0
    ds_write_b32 v2, v161 offset:32
    ds_write_b32 v2, v162 offset:64
    ds_write_b32 v2, v163 offset:96
    s_waitcnt lgkmcnt(0)
    s_barrier
    s_waitcnt vmcnt(0)
    s_endpgm
HELPER:
    s_sub_u32 s4, s3, 8
    s_mov_b32 s56, s42
    s_mov_b32 s57, s43
    s_mov_b32 s58, 524288
    s_mov_b32 s59, 0x00020000
    s_mov_b32 s64, s40
    s_mov_b32 s65, s41
    s_mov_b32 s66, 256
    s_mov_b32 s67, 0x00020000
    s_mov_b32 s68, s16
    s_mov_b32 s69, s17
    s_mov_b32 s70, 4096
    s_mov_b32 s71, 0x00020000
    v_mov_b32 v2, 0
    v_lshlrev_b32 v1, 2, v0
    v_add_u32 v3, 114688, v1
    s_cmp_lg_u32 s4, 0
    s_cbranch_scc1 H_NOZ
    ds_write_b32 v3, v2
H_NOZ:
    s_cmp_ge_u32 s2, 96
    s_cbranch_scc1 H_NOML
    s_mov_b32 s52, s36
    s_mov_b32 s53, s37
    s_mov_b32 s54, 3145728
    s_mov_b32 s55, 0x00020000
    s_mov_b32 s72, s34
    s_mov_b32 s73, s35
    s_mov_b32 s74, 4096
    s_mov_b32 s75, 0x00020000
    s_and_b32 s8, s2, 3
    s_lshl_b32 s8, s8, 7
    s_lshl_b32 s9, s4, 5
    s_add_u32 s8, s8, s9
    v_and_b32 v2, 7, v0
    v_lshrrev_b32 v3, 4, v0
    v_lshl_add_u32 v2, v2, 2, v3
    v_lshlrev_b32 v2, 1, v2
    s_lshl_b32 s9, s8, 1
    buffer_load_ushort v8, v2, s[72:75], s9 offen offset:0
    buffer_load_ushort v9, v2, s[72:75], s9 offen offset:1024
    buffer_load_ushort v10, v2, s[72:75], s9 offen offset:2048
    buffer_load_ushort v11, v2, s[72:75], s9 offen offset:3072
    s_mov_b32 s10, 6144
    v_mul_lo_u32 v2, v3, s10
    v_and_b32 v3, 15, v0
    v_lshl_add_u32 v2, v3, 4, v2
    s_mul_i32 s8, s8, 6144
    s_lshr_b32 s9, s2, 2
    s_lshl_b32 s9, s9, 8
    s_add_u32 s8, s8, s9
    buffer_load_dwordx4 v[32:35], v2, s[52:55], s8 offen
    s_add_u32 s8, s8, 24576
    buffer_load_dwordx4 v[36:39], v2, s[52:55], s8 offen
    s_add_u32 s8, s8, 24576
    buffer_load_dwordx4 v[40:43], v2, s[52:55], s8 offen
    s_add_u32 s8, s8, 24576
    buffer_load_dwordx4 v[44:47], v2, s[52:55], s8 offen
    s_add_u32 s8, s8, 24576
    buffer_load_dwordx4 v[48:51], v2, s[52:55], s8 offen
    s_add_u32 s8, s8, 24576
    buffer_load_dwordx4 v[52:55], v2, s[52:55], s8 offen
    s_add_u32 s8, s8, 24576
    buffer_load_dwordx4 v[56:59], v2, s[52:55], s8 offen
    s_add_u32 s8, s8, 24576
    buffer_load_dwordx4 v[60:63], v2, s[52:55], s8 offen
H_NOML:
    s_lshl_b32 s8, s5, 10
    v_lshlrev_b32 v1, 4, v0
    buffer_load_dwordx4 v[24:27], v1, s[68:71], s8 offen
    s_lshl_b32 s9, s4, 8
    s_add_u32 s8, s8, s9
    v_lshlrev_b32 v2, 2, v0
    buffer_load_dword v28, v2, s[68:71], s8 offen
    s_waitcnt lgkmcnt(0)
    s_barrier
    v_and_b32 v3, 1, v0
    v_lshlrev_b32 v3, 4, v3
    v_mov_b32 v2, 0xffff
    v_lshlrev_b32 v2, v3, v2
    v_and_b32 v3, 15, v0
    v_lshrrev_b32 v3, 1, v3
    v_cmp_eq_u32 vcc, 0, v3
    s_nop 1
    v_cndmask_b32 v164, 0, v2, vcc
    v_cmp_eq_u32 vcc, 1, v3
    s_nop 1
    v_cndmask_b32 v165, 0, v2, vcc
    v_cmp_eq_u32 vcc, 2, v3
    s_nop 1
    v_cndmask_b32 v166, 0, v2, vcc
    v_cmp_eq_u32 vcc, 3, v3
    s_nop 1
    v_cndmask_b32 v167, 0, v2, vcc
    s_cmp_ge_u32 s2, 96
    s_cbranch_scc1 H_NOMOD
    v_or_b32_dpp v12, v164, v164 row_ror:8 row_mask:0xf bank_mask:0xf
    v_or_b32_dpp v13, v165, v165 row_ror:8 row_mask:0xf bank_mask:0xf
    v_or_b32_dpp v14, v166, v166 row_ror:8 row_mask:0xf bank_mask:0xf
    v_or_b32_dpp v15, v167, v167 row_ror:8 row_mask:0xf bank_mask:0xf
    s_waitcnt vmcnt(10)
    v_lshlrev_b32 v8, 16, v8
    v_mul_f32 v4, 0xbfb8aa3b, v8
    v_exp_f32 v4, v4
    v_lshlrev_b32 v9, 16, v9
    v_mul_f32 v5, 0xbfb8aa3b, v9
    v_exp_f32 v5, v5
    v_lshlrev_b32 v10, 16, v10
    v_mul_f32 v6, 0xbfb8aa3b, v10
    v_exp_f32 v6, v6
    v_lshlrev_b32 v11, 16, v11
    v_mul_f32 v7, 0xbfb8aa3b, v11
    v_exp_f32 v7, v7
    v_add_f32 v4, 1.0, v4
    v_rcp_f32 v4, v4
    v_add_f32 v5, 1.0, v5
    v_rcp_f32 v5, v5
    v_add_f32 v6, 1.0, v6
    v_rcp_f32 v6, v6
    v_add_f32 v7, 1.0, v7
    v_rcp_f32 v7, v7
    v_mul_f32 v8, v8, v4
    v_cvt_pk_bf16_f32 v8, v8, v8
    v_mul_f32 v9, v9, v5
    v_cvt_pk_bf16_f32 v9, v9, v9
    v_mul_f32 v10, v10, v6
    v_cvt_pk_bf16_f32 v10, v10, v10
    v_mul_f32 v11, v11, v7
    v_cvt_pk_bf16_f32 v11, v11, v11
    s_waitcnt vmcnt(9)
    v_and_b32_dpp v16, v8, v12 row_newbcast:0 row_mask:0xf bank_mask:0x3
    v_and_b32_dpp v17, v8, v13 row_newbcast:0 row_mask:0xf bank_mask:0x3
    v_and_b32_dpp v18, v8, v14 row_newbcast:0 row_mask:0xf bank_mask:0x3
    v_and_b32_dpp v19, v8, v15 row_newbcast:0 row_mask:0xf bank_mask:0x3
    v_and_b32_dpp v16, v9, v12 row_newbcast:0 row_mask:0xf bank_mask:0xc
    v_and_b32_dpp v17, v9, v13 row_newbcast:0 row_mask:0xf bank_mask:0xc
    v_and_b32_dpp v18, v9, v14 row_newbcast:0 row_mask:0xf bank_mask:0xc
    v_and_b32_dpp v19, v9, v15 row_newbcast:0 row_mask:0xf bank_mask:0xc
    s_nop 1
    v_mfma_f32_16x16x32_bf16 v[96:99], v[32:35], v[16:19], 0
    v_and_b32_dpp v20, v10, v12 row_newbcast:0 row_mask:0xf bank_mask:0x3
    v_and_b32_dpp v21, v10, v13 row_newbcast:0 row_mask:0xf bank_mask:0x3
    v_and_b32_dpp v22, v10, v14 row_newbcast:0 row_mask:0xf bank_mask:0x3
    v_and_b32_dpp v23, v10, v15 row_newbcast:0 row_mask:0xf bank_mask:0x3
    v_and_b32_dpp v20, v11, v12 row_newbcast:0 row_mask:0xf bank_mask:0xc
    v_and_b32_dpp v21, v11, v13 row_newbcast:0 row_mask:0xf bank_mask:0xc
    v_and_b32_dpp v22, v11, v14 row_newbcast:0 row_mask:0xf bank_mask:0xc
    v_and_b32_dpp v23, v11, v15 row_newbcast:0 row_mask:0xf bank_mask:0xc
    s_nop 1
    v_mfma_f32_16x16x32_bf16 v[100:103], v[32:35], v[20:23], 0
    s_waitcnt vmcnt(8)
    v_and_b32_dpp v16, v8, v12 row_newbcast:1 row_mask:0xf bank_mask:0x3
    v_and_b32_dpp v17, v8, v13 row_newbcast:1 row_mask:0xf bank_mask:0x3
    v_and_b32_dpp v18, v8, v14 row_newbcast:1 row_mask:0xf bank_mask:0x3
    v_and_b32_dpp v19, v8, v15 row_newbcast:1 row_mask:0xf bank_mask:0x3
    v_and_b32_dpp v16, v9, v12 row_newbcast:1 row_mask:0xf bank_mask:0xc
    v_and_b32_dpp v17, v9, v13 row_newbcast:1 row_mask:0xf bank_mask:0xc
    v_and_b32_dpp v18, v9, v14 row_newbcast:1 row_mask:0xf bank_mask:0xc
    v_and_b32_dpp v19, v9, v15 row_newbcast:1 row_mask:0xf bank_mask:0xc
    s_nop 1
    v_mfma_f32_16x16x32_bf16 v[96:99], v[36:39], v[16:19], v[96:99]
    v_and_b32_dpp v20, v10, v12 row_newbcast:1 row_mask:0xf bank_mask:0x3
    v_and_b32_dpp v21, v10, v13 row_newbcast:1 row_mask:0xf bank_mask:0x3
    v_and_b32_dpp v22, v10, v14 row_newbcast:1 row_mask:0xf bank_mask:0x3
    v_and_b32_dpp v23, v10, v15 row_newbcast:1 row_mask:0xf bank_mask:0x3
    v_and_b32_dpp v20, v11, v12 row_newbcast:1 row_mask:0xf bank_mask:0xc
    v_and_b32_dpp v21, v11, v13 row_newbcast:1 row_mask:0xf bank_mask:0xc
    v_and_b32_dpp v22, v11, v14 row_newbcast:1 row_mask:0xf bank_mask:0xc
    v_and_b32_dpp v23, v11, v15 row_newbcast:1 row_mask:0xf bank_mask:0xc
    s_nop 1
    v_mfma_f32_16x16x32_bf16 v[100:103], v[36:39], v[20:23], v[100:103]
    s_waitcnt vmcnt(7)
    v_and_b32_dpp v16, v8, v12 row_newbcast:2 row_mask:0xf bank_mask:0x3
    v_and_b32_dpp v17, v8, v13 row_newbcast:2 row_mask:0xf bank_mask:0x3
    v_and_b32_dpp v18, v8, v14 row_newbcast:2 row_mask:0xf bank_mask:0x3
    v_and_b32_dpp v19, v8, v15 row_newbcast:2 row_mask:0xf bank_mask:0x3
    v_and_b32_dpp v16, v9, v12 row_newbcast:2 row_mask:0xf bank_mask:0xc
    v_and_b32_dpp v17, v9, v13 row_newbcast:2 row_mask:0xf bank_mask:0xc
    v_and_b32_dpp v18, v9, v14 row_newbcast:2 row_mask:0xf bank_mask:0xc
    v_and_b32_dpp v19, v9, v15 row_newbcast:2 row_mask:0xf bank_mask:0xc
    s_nop 1
    v_mfma_f32_16x16x32_bf16 v[96:99], v[40:43], v[16:19], v[96:99]
    v_and_b32_dpp v20, v10, v12 row_newbcast:2 row_mask:0xf bank_mask:0x3
    v_and_b32_dpp v21, v10, v13 row_newbcast:2 row_mask:0xf bank_mask:0x3
    v_and_b32_dpp v22, v10, v14 row_newbcast:2 row_mask:0xf bank_mask:0x3
    v_and_b32_dpp v23, v10, v15 row_newbcast:2 row_mask:0xf bank_mask:0x3
    v_and_b32_dpp v20, v11, v12 row_newbcast:2 row_mask:0xf bank_mask:0xc
    v_and_b32_dpp v21, v11, v13 row_newbcast:2 row_mask:0xf bank_mask:0xc
    v_and_b32_dpp v22, v11, v14 row_newbcast:2 row_mask:0xf bank_mask:0xc
    v_and_b32_dpp v23, v11, v15 row_newbcast:2 row_mask:0xf bank_mask:0xc
    s_nop 1
    v_mfma_f32_16x16x32_bf16 v[100:103], v[40:43], v[20:23], v[100:103]
    s_waitcnt vmcnt(6)
    v_and_b32_dpp v16, v8, v12 row_newbcast:3 row_mask:0xf bank_mask:0x3
    v_and_b32_dpp v17, v8, v13 row_newbcast:3 row_mask:0xf bank_mask:0x3
    v_and_b32_dpp v18, v8, v14 row_newbcast:3 row_mask:0xf bank_mask:0x3
    v_and_b32_dpp v19, v8, v15 row_newbcast:3 row_mask:0xf bank_mask:0x3
    v_and_b32_dpp v16, v9, v12 row_newbcast:3 row_mask:0xf bank_mask:0xc
    v_and_b32_dpp v17, v9, v13 row_newbcast:3 row_mask:0xf bank_mask:0xc
    v_and_b32_dpp v18, v9, v14 row_newbcast:3 row_mask:0xf bank_mask:0xc
    v_and_b32_dpp v19, v9, v15 row_newbcast:3 row_mask:0xf bank_mask:0xc
    s_nop 1
    v_mfma_f32_16x16x32_bf16 v[96:99], v[44:47], v[16:19], v[96:99]
    v_and_b32_dpp v20, v10, v12 row_newbcast:3 row_mask:0xf bank_mask:0x3
    v_and_b32_dpp v21, v10, v13 row_newbcast:3 row_mask:0xf bank_mask:0x3
    v_and_b32_dpp v22, v10, v14 row_newbcast:3 row_mask:0xf bank_mask:0x3
    v_and_b32_dpp v23, v10, v15 row_newbcast:3 row_mask:0xf bank_mask:0x3
    v_and_b32_dpp v20, v11, v12 row_newbcast:3 row_mask:0xf bank_mask:0xc
    v_and_b32_dpp v21, v11, v13 row_newbcast:3 row_mask:0xf bank_mask:0xc
    v_and_b32_dpp v22, v11, v14 row_newbcast:3 row_mask:0xf bank_mask:0xc
    v_and_b32_dpp v23, v11, v15 row_newbcast:3 row_mask:0xf bank_mask:0xc
    s_nop 1
    v_mfma_f32_16x16x32_bf16 v[100:103], v[44:47], v[20:23], v[100:103]
    s_waitcnt vmcnt(5)
    v_and_b32_dpp v16, v8, v12 row_newbcast:4 row_mask:0xf bank_mask:0x3
    v_and_b32_dpp v17, v8, v13 row_newbcast:4 row_mask:0xf bank_mask:0x3
    v_and_b32_dpp v18, v8, v14 row_newbcast:4 row_mask:0xf bank_mask:0x3
    v_and_b32_dpp v19, v8, v15 row_newbcast:4 row_mask:0xf bank_mask:0x3
    v_and_b32_dpp v16, v9, v12 row_newbcast:4 row_mask:0xf bank_mask:0xc
    v_and_b32_dpp v17, v9, v13 row_newbcast:4 row_mask:0xf bank_mask:0xc
    v_and_b32_dpp v18, v9, v14 row_newbcast:4 row_mask:0xf bank_mask:0xc
    v_and_b32_dpp v19, v9, v15 row_newbcast:4 row_mask:0xf bank_mask:0xc
    s_nop 1
    v_mfma_f32_16x16x32_bf16 v[96:99], v[48:51], v[16:19], v[96:99]
    v_and_b32_dpp v20, v10, v12 row_newbcast:4 row_mask:0xf bank_mask:0x3
    v_and_b32_dpp v21, v10, v13 row_newbcast:4 row_mask:0xf bank_mask:0x3
    v_and_b32_dpp v22, v10, v14 row_newbcast:4 row_mask:0xf bank_mask:0x3
    v_and_b32_dpp v23, v10, v15 row_newbcast:4 row_mask:0xf bank_mask:0x3
    v_and_b32_dpp v20, v11, v12 row_newbcast:4 row_mask:0xf bank_mask:0xc
    v_and_b32_dpp v21, v11, v13 row_newbcast:4 row_mask:0xf bank_mask:0xc
    v_and_b32_dpp v22, v11, v14 row_newbcast:4 row_mask:0xf bank_mask:0xc
    v_and_b32_dpp v23, v11, v15 row_newbcast:4 row_mask:0xf bank_mask:0xc
    s_nop 1
    v_mfma_f32_16x16x32_bf16 v[100:103], v[48:51], v[20:23], v[100:103]
    s_waitcnt vmcnt(4)
    v_and_b32_dpp v16, v8, v12 row_newbcast:5 row_mask:0xf bank_mask:0x3
    v_and_b32_dpp v17, v8, v13 row_newbcast:5 row_mask:0xf bank_mask:0x3
    v_and_b32_dpp v18, v8, v14 row_newbcast:5 row_mask:0xf bank_mask:0x3
    v_and_b32_dpp v19, v8, v15 row_newbcast:5 row_mask:0xf bank_mask:0x3
    v_and_b32_dpp v16, v9, v12 row_newbcast:5 row_mask:0xf bank_mask:0xc
    v_and_b32_dpp v17, v9, v13 row_newbcast:5 row_mask:0xf bank_mask:0xc
    v_and_b32_dpp v18, v9, v14 row_newbcast:5 row_mask:0xf bank_mask:0xc
    v_and_b32_dpp v19, v9, v15 row_newbcast:5 row_mask:0xf bank_mask:0xc
    s_nop 1
    v_mfma_f32_16x16x32_bf16 v[96:99], v[52:55], v[16:19], v[96:99]
    v_and_b32_dpp v20, v10, v12 row_newbcast:5 row_mask:0xf bank_mask:0x3
    v_and_b32_dpp v21, v10, v13 row_newbcast:5 row_mask:0xf bank_mask:0x3
    v_and_b32_dpp v22, v10, v14 row_newbcast:5 row_mask:0xf bank_mask:0x3
    v_and_b32_dpp v23, v10, v15 row_newbcast:5 row_mask:0xf bank_mask:0x3
    v_and_b32_dpp v20, v11, v12 row_newbcast:5 row_mask:0xf bank_mask:0xc
    v_and_b32_dpp v21, v11, v13 row_newbcast:5 row_mask:0xf bank_mask:0xc
    v_and_b32_dpp v22, v11, v14 row_newbcast:5 row_mask:0xf bank_mask:0xc
    v_and_b32_dpp v23, v11, v15 row_newbcast:5 row_mask:0xf bank_mask:0xc
    s_nop 1
    v_mfma_f32_16x16x32_bf16 v[100:103], v[52:55], v[20:23], v[100:103]
    s_waitcnt vmcnt(3)
    v_and_b32_dpp v16, v8, v12 row_newbcast:6 row_mask:0xf bank_mask:0x3
    v_and_b32_dpp v17, v8, v13 row_newbcast:6 row_mask:0xf bank_mask:0x3
    v_and_b32_dpp v18, v8, v14 row_newbcast:6 row_mask:0xf bank_mask:0x3
    v_and_b32_dpp v19, v8, v15 row_newbcast:6 row_mask:0xf bank_mask:0x3
    v_and_b32_dpp v16, v9, v12 row_newbcast:6 row_mask:0xf bank_mask:0xc
    v_and_b32_dpp v17, v9, v13 row_newbcast:6 row_mask:0xf bank_mask:0xc
    v_and_b32_dpp v18, v9, v14 row_newbcast:6 row_mask:0xf bank_mask:0xc
    v_and_b32_dpp v19, v9, v15 row_newbcast:6 row_mask:0xf bank_mask:0xc
    s_nop 1
    v_mfma_f32_16x16x32_bf16 v[96:99], v[56:59], v[16:19], v[96:99]
    v_and_b32_dpp v20, v10, v12 row_newbcast:6 row_mask:0xf bank_mask:0x3
    v_and_b32_dpp v21, v10, v13 row_newbcast:6 row_mask:0xf bank_mask:0x3
    v_and_b32_dpp v22, v10, v14 row_newbcast:6 row_mask:0xf bank_mask:0x3
    v_and_b32_dpp v23, v10, v15 row_newbcast:6 row_mask:0xf bank_mask:0x3
    v_and_b32_dpp v20, v11, v12 row_newbcast:6 row_mask:0xf bank_mask:0xc
    v_and_b32_dpp v21, v11, v13 row_newbcast:6 row_mask:0xf bank_mask:0xc
    v_and_b32_dpp v22, v11, v14 row_newbcast:6 row_mask:0xf bank_mask:0xc
    v_and_b32_dpp v23, v11, v15 row_newbcast:6 row_mask:0xf bank_mask:0xc
    s_nop 1
    v_mfma_f32_16x16x32_bf16 v[100:103], v[56:59], v[20:23], v[100:103]
    s_waitcnt vmcnt(2)
    v_and_b32_dpp v16, v8, v12 row_newbcast:7 row_mask:0xf bank_mask:0x3
    v_and_b32_dpp v17, v8, v13 row_newbcast:7 row_mask:0xf bank_mask:0x3
    v_and_b32_dpp v18, v8, v14 row_newbcast:7 row_mask:0xf bank_mask:0x3
    v_and_b32_dpp v19, v8, v15 row_newbcast:7 row_mask:0xf bank_mask:0x3
    v_and_b32_dpp v16, v9, v12 row_newbcast:7 row_mask:0xf bank_mask:0xc
    v_and_b32_dpp v17, v9, v13 row_newbcast:7 row_mask:0xf bank_mask:0xc
    v_and_b32_dpp v18, v9, v14 row_newbcast:7 row_mask:0xf bank_mask:0xc
    v_and_b32_dpp v19, v9, v15 row_newbcast:7 row_mask:0xf bank_mask:0xc
    s_nop 1
    v_mfma_f32_16x16x32_bf16 v[96:99], v[60:63], v[16:19], v[96:99]
    v_and_b32_dpp v20, v10, v12 row_newbcast:7 row_mask:0xf bank_mask:0x3
    v_and_b32_dpp v21, v10, v13 row_newbcast:7 row_mask:0xf bank_mask:0x3
    v_and_b32_dpp v22, v10, v14 row_newbcast:7 row_mask:0xf bank_mask:0x3
    v_and_b32_dpp v23, v10, v15 row_newbcast:7 row_mask:0xf bank_mask:0x3
    v_and_b32_dpp v20, v11, v12 row_newbcast:7 row_mask:0xf bank_mask:0xc
    v_and_b32_dpp v21, v11, v13 row_newbcast:7 row_mask:0xf bank_mask:0xc
    v_and_b32_dpp v22, v11, v14 row_newbcast:7 row_mask:0xf bank_mask:0xc
    v_and_b32_dpp v23, v11, v15 row_newbcast:7 row_mask:0xf bank_mask:0xc
    s_nop 1
    v_mfma_f32_16x16x32_bf16 v[100:103], v[60:63], v[20:23], v[100:103]
    v_lshrrev_b32 v2, 4, v0
    v_lshlrev_b32 v2, 7, v2
    v_and_b32 v3, 7, v0
    v_lshl_add_u32 v2, v3, 2, v2
    v_and_b32 v3, 8, v0
    v_lshl_add_u32 v2, v3, 6, v2
    s_lshl_b32 s8, s4, 11
    v_add_u32 v2, s8, v2
    ds_write_b32 v2, v96 offset:0
    ds_write_b32 v2, v97 offset:32
    ds_write_b32 v2, v98 offset:64
    ds_write_b32 v2, v99 offset:96
    ds_write_b32 v2, v100 offset:1024
    ds_write_b32 v2, v101 offset:1056
    ds_write_b32 v2, v102 offset:1088
    ds_write_b32 v2, v103 offset:1120
    v_mov_b32 v3, 114688
    v_mov_b32 v2, 1
    s_mov_b64 exec, 1
    s_waitcnt lgkmcnt(0)
    ds_add_rtn_u32 v4, v3, v2 offset:0
    s_waitcnt lgkmcnt(0)
    s_mov_b64 exec, -1
    v_readfirstlane_b32 s9, v4
    s_cmp_lg_u32 s9, 3
    s_nop 2
    s_cbranch_scc1 H_NOMOD
    v_lshlrev_b32 v4, 5, v0
    ds_read_b128 v[96:99], v4 offset:0
    ds_read_b128 v[100:103], v4 offset:16
    ds_read_b128 v[104:107], v4 offset:2048
    ds_read_b128 v[108:111], v4 offset:2064
    ds_read_b128 v[112:115], v4 offset:4096
    ds_read_b128 v[116:119], v4 offset:4112
    ds_read_b128 v[120:123], v4 offset:6144
    ds_read_b128 v[124:127], v4 offset:6160
    v_lshrrev_b32 v4, 4, v0
    s_mov_b32 s10, 12288
    v_mul_lo_u32 v4, v4, s10
    v_and_b32 v3, 15, v0
    v_lshl_add_u32 v4, v3, 5, v4
    s_and_b32 s8, s2, 3
    s_mul_i32 s8, s8, 49152
    s_lshr_b32 s9, s2, 2
    s_lshl_b32 s9, s9, 9
    s_add_u32 s8, s8, s9
    s_waitcnt lgkmcnt(0)
    v_add_f32 v96, v96, v104
    v_add_f32 v112, v112, v120
    v_add_f32 v97, v97, v105
    v_add_f32 v113, v113, v121
    v_add_f32 v98, v98, v106
    v_add_f32 v114, v114, v122
    v_add_f32 v99, v99, v107
    v_add_f32 v115, v115, v123
    v_add_f32 v100, v100, v108
    v_add_f32 v116, v116, v124
    v_add_f32 v101, v101, v109
    v_add_f32 v117, v117, v125
    v_add_f32 v102, v102, v110
    v_add_f32 v118, v118, v126
    v_add_f32 v103, v103, v111
    v_add_f32 v119, v119, v127
    v_add_f32 v96, v96, v112
    v_add_f32 v97, v97, v113
    v_add_f32 v98, v98, v114
    v_add_f32 v99, v99, v115
    v_add_f32 v100, v100, v116
    v_add_f32 v101, v101, v117
    v_add_f32 v102, v102, v118
    v_add_f32 v103, v103, v119
    buffer_store_dwordx4 v[96:99], v4, s[56:59], s8 offen sc1
    buffer_store_dwordx4 v[100:103], v4, s[56:59], s8 offen offset:16 sc1
    s_cmp_lt_u32 s2, 32
    s_cselect_b32 s9, 4, 68
    v_mov_b32 v3, s9
    s_mov_b64 exec, 1
    s_waitcnt vmcnt(0)
    buffer_atomic_add v2, v3, s[64:67], 0 offen sc1
    s_mov_b64 exec, -1
H_NOMOD:
    s_mov_b32 s74, 0x3fb8aa3b
    s_mov_b32 s52, s22
    s_mov_b32 s53, s23
    s_mov_b32 s54, 4194304
    s_mov_b32 s55, 0x00020000
    v_lshrrev_b32 v2, 4, v0
    v_lshlrev_b32 v2, 18, v2
    v_and_b32 v3, 15, v0
    v_lshl_add_u32 v2, v3, 4, v2
    s_lshl_b32 s8, s4, 20
    s_lshl_b32 s9, s6, 8
    s_add_u32 s8, s8, s9
    buffer_load_dwordx4 v[32:35], v2, s[52:55], s8 offen
    s_add_u32 s8, s8, 0x4000
    buffer_load_dwordx4 v[36:39], v2, s[52:55], s8 offen
    s_add_u32 s8, s8, 0x4000
    buffer_load_dwordx4 v[40:43], v2, s[52:55], s8 offen
    s_add_u32 s8, s8, 0x4000
    buffer_load_dwordx4 v[44:47], v2, s[52:55], s8 offen
    s_add_u32 s8, s8, 0x4000
    buffer_load_dwordx4 v[48:51], v2, s[52:55], s8 offen
    s_add_u32 s8, s8, 0x4000
    buffer_load_dwordx4 v[52:55], v2, s[52:55], s8 offen
    s_add_u32 s8, s8, 0x4000
    buffer_load_dwordx4 v[56:59], v2, s[52:55], s8 offen
    s_add_u32 s8, s8, 0x4000
    buffer_load_dwordx4 v[60:63], v2, s[52:55], s8 offen
    s_add_u32 s8, s8, 0x4000
    buffer_load_dwordx4 v[64:67], v2, s[52:55], s8 offen
    s_add_u32 s8, s8, 0x4000
    buffer_load_dwordx4 v[68:71], v2, s[52:55], s8 offen
    s_add_u32 s8, s8, 0x4000
    buffer_load_dwordx4 v[72:75], v2, s[52:55], s8 offen
    s_add_u32 s8, s8, 0x4000
    buffer_load_dwordx4 v[76:79], v2, s[52:55], s8 offen
    s_add_u32 s8, s8, 0x4000
    buffer_load_dwordx4 v[80:83], v2, s[52:55], s8 offen
    s_add_u32 s8, s8, 0x4000
    buffer_load_dwordx4 v[84:87], v2, s[52:55], s8 offen
    s_add_u32 s8, s8, 0x4000
    buffer_load_dwordx4 v[88:91], v2, s[52:55], s8 offen
    s_add_u32 s8, s8, 0x4000
    buffer_load_dwordx4 v[92:95], v2, s[52:55], s8 offen
    s_sub_u32 s8, s8, 237568
    buffer_load_dwordx4 v[96:99], v2, s[52:55], s8 offen
    s_add_u32 s8, s8, 0x4000
    buffer_load_dwordx4 v[100:103], v2, s[52:55], s8 offen
    s_add_u32 s8, s8, 0x4000
    buffer_load_dwordx4 v[104:107], v2, s[52:55], s8 offen
    s_add_u32 s8, s8, 0x4000
    buffer_load_dwordx4 v[108:111], v2, s[52:55], s8 offen
    s_add_u32 s8, s8, 0x4000
    buffer_load_dwordx4 v[112:115], v2, s[52:55], s8 offen
    s_add_u32 s8, s8, 0x4000
    buffer_load_dwordx4 v[116:119], v2, s[52:55], s8 offen
    s_add_u32 s8, s8, 0x4000
    buffer_load_dwordx4 v[120:123], v2, s[52:55], s8 offen
    s_add_u32 s8, s8, 0x4000
    buffer_load_dwordx4 v[124:127], v2, s[52:55], s8 offen
    s_add_u32 s8, s8, 0x4000
    buffer_load_dwordx4 v[128:131], v2, s[52:55], s8 offen
    s_add_u32 s8, s8, 0x4000
    buffer_load_dwordx4 v[132:135], v2, s[52:55], s8 offen
    s_add_u32 s8, s8, 0x4000
    buffer_load_dwordx4 v[136:139], v2, s[52:55], s8 offen
    s_add_u32 s8, s8, 0x4000
    buffer_load_dwordx4 v[140:143], v2, s[52:55], s8 offen
    s_add_u32 s8, s8, 0x4000
    buffer_load_dwordx4 v[144:147], v2, s[52:55], s8 offen
    s_add_u32 s8, s8, 0x4000
    buffer_load_dwordx4 v[148:151], v2, s[52:55], s8 offen
    s_add_u32 s8, s8, 0x4000
    buffer_load_dwordx4 v[152:155], v2, s[52:55], s8 offen
    s_add_u32 s8, s8, 0x4000
    buffer_load_dwordx4 v[156:159], v2, s[52:55], s8 offen
    s_waitcnt vmcnt(32)
    v_lshlrev_b32 v8, 16, v24
    v_and_b32 v9, 0xffff0000, v24
    v_lshlrev_b32 v10, 16, v25
    v_and_b32 v11, 0xffff0000, v25
    v_lshlrev_b32 v12, 16, v26
    v_and_b32 v13, 0xffff0000, v26
    v_lshlrev_b32 v14, 16, v27
    v_and_b32 v15, 0xffff0000, v27
    v_add_f32 v2, v8, v9
    v_add_f32 v2, v2, v10
    v_add_f32 v2, v2, v11
    v_add_f32 v2, v2, v12
    v_add_f32 v2, v2, v13
    v_add_f32 v2, v2, v14
    v_add_f32 v2, v2, v15
    s_nop 1
    v_add_f32_dpp v2, v2, v2 row_ror:8 row_mask:0xf bank_mask:0xf
    s_nop 1
    v_add_f32_dpp v2, v2, v2 row_ror:4 row_mask:0xf bank_mask:0xf
    s_nop 1
    v_add_f32_dpp v2, v2, v2 row_ror:2 row_mask:0xf bank_mask:0xf
    s_nop 1
    v_add_f32_dpp v2, v2, v2 row_ror:1 row_mask:0xf bank_mask:0xf
    v_mov_b32 v3, v2
    s_nop 1
    v_permlane16_swap_b32 v2, v3
    v_add_f32 v2, v2, v3
    v_mov_b32 v3, v2
    s_nop 1
    v_permlane32_swap_b32 v2, v3
    v_add_f32 v2, v2, v3
    v_mul_f32 v2, 0x3b000000, v2
    v_sub_f32 v4, v8, v2
    v_mul_f32 v6, v4, v4
    v_sub_f32 v4, v9, v2
    v_fmac_f32 v6, v4, v4
    v_sub_f32 v4, v10, v2
    v_fmac_f32 v6, v4, v4
    v_sub_f32 v4, v11, v2
    v_fmac_f32 v6, v4, v4
    v_sub_f32 v4, v12, v2
    v_fmac_f32 v6, v4, v4
    v_sub_f32 v4, v13, v2
    v_fmac_f32 v6, v4, v4
    v_sub_f32 v4, v14, v2
    v_fmac_f32 v6, v4, v4
    v_sub_f32 v4, v15, v2
    v_fmac_f32 v6, v4, v4
    s_nop 1
    v_add_f32_dpp v6, v6, v6 row_ror:8 row_mask:0xf bank_mask:0xf
    s_nop 1
    v_add_f32_dpp v6, v6, v6 row_ror:4 row_mask:0xf bank_mask:0xf
    s_nop 1
    v_add_f32_dpp v6, v6, v6 row_ror:2 row_mask:0xf bank_mask:0xf
    s_nop 1
    v_add_f32_dpp v6, v6, v6 row_ror:1 row_mask:0xf bank_mask:0xf
    v_mov_b32 v3, v6
    s_nop 1
    v_permlane16_swap_b32 v6, v3
    v_add_f32 v6, v6, v3
    v_mov_b32 v3, v6
    s_nop 1
    v_permlane32_swap_b32 v6, v3
    v_add_f32 v6, v6, v3
    v_mul_f32 v6, 0x3b000000, v6
    v_mov_b32 v5, v2
    v_cvt_pk_bf16_f32 v3, v5, v6
    v_lshlrev_b32 v5, 16, v3
    v_and_b32 v6, 0xffff0000, v3
    v_add_f32 v6, 0x3727c5ac, v6
    v_cvt_pk_bf16_f32 v6, v6, v6
    v_and_b32 v6, 0xffff0000, v6
    v_sqrt_f32 v6, v6
    s_nop 0
    v_cvt_pk_bf16_f32 v6, v6, v6
    v_and_b32 v6, 0xffff0000, v6
    v_rcp_f32 v6, v6
    v_and_b32 v29, 0xffff0000, v28
    v_lshlrev_b32 v28, 16, v28
    v_sub_f32 v28, v28, v5
    v_sub_f32 v29, v29, v5
    v_cvt_pk_bf16_f32 v2, v28, v29
    v_lshlrev_b32 v28, 16, v2
    v_and_b32 v29, 0xffff0000, v2
    v_mul_f32 v28, v28, v6
    v_mul_f32 v29, v29, v6
    v_cvt_pk_bf16_f32 v2, v28, v29
    v_lshlrev_b32 v28, 16, v2
    v_and_b32 v29, 0xffff0000, v2
    v_mov_b32 v3, 114688
    s_cmp_lg_u32 s4, 0
    s_cbranch_scc1 H_WFLAG
    v_mov_b32 v2, 0
    s_mov_b64 exec, 1
    s_mov_b32 s15, 16384
POLL_1:
    buffer_load_dword v4, v2, s[64:67], 0 offen offset:4 sc1
    s_waitcnt vmcnt(0)
    v_cmp_gt_u32 vcc, 32, v4
    s_nop 3
    s_cbranch_vccz PDONE_2
    s_sub_u32 s15, s15, 1
    s_cmp_eq_u32 s15, 0
    s_cbranch_scc1 PDONE_2
    s_sleep 2
    s_branch POLL_1
PDONE_2:
    v_mov_b32 v4, 1
    ds_write_b32 v3, v4 offset:4
    s_mov_b64 exec, -1
    s_branch H_GOTC0
H_WFLAG:
    s_mov_b32 s15, 262144
LP_3:
    ds_read_b32 v4, v3 offset:4
    s_waitcnt lgkmcnt(0)
    v_cmp_gt_u32 vcc, 1, v4
    s_nop 3
    s_cbranch_vccz LPD_4
    s_sub_u32 s15, s15, 1
    s_cmp_eq_u32 s15, 0
    s_cbranch_scc1 LPD_4
    s_sleep 1
    s_branch LP_3
LPD_4:
H_GOTC0:
    s_mul_i32 s8, s5, 12288
    s_lshl_b32 s9, s4, 9
    s_add_u32 s8, s8, s9
    v_lshlrev_b32 v2, 3, v0
    buffer_load_dwordx2 v[8:9], v2, s[56:59], s8 offen sc1
    buffer_load_dwordx2 v[10:11], v2, s[56:59], s8 offen offset:2048 sc1
    s_add_u32 s8, s8, 49152
    buffer_load_dwordx2 v[12:13], v2, s[56:59], s8 offen sc1
    buffer_load_dwordx2 v[14:15], v2, s[56:59], s8 offen offset:2048 sc1
    s_add_u32 s8, s8, 49152
    buffer_load_dwordx2 v[16:17], v2, s[56:59], s8 offen sc1
    buffer_load_dwordx2 v[18:19], v2, s[56:59], s8 offen offset:2048 sc1
    s_add_u32 s8, s8, 49152
    buffer_load_dwordx2 v[20:21], v2, s[56:59], s8 offen sc1
    buffer_load_dwordx2 v[22:23], v2, s[56:59], s8 offen offset:2048 sc1
    s_waitcnt vmcnt(0)
    v_add_f32 v8, v8, v12
    v_add_f32 v16, v16, v20
    v_add_f32 v9, v9, v13
    v_add_f32 v17, v17, v21
    v_add_f32 v10, v10, v14
    v_add_f32 v18, v18, v22
    v_add_f32 v11, v11, v15
    v_add_f32 v19, v19, v23
    v_add_f32 v8, v8, v16
    v_add_f32 v9, v9, v17
    v_add_f32 v10, v10, v18
    v_add_f32 v11, v11, v19
    v_cvt_pk_bf16_f32 v2, v8, v9
    v_lshlrev_b32 v8, 16, v2
    v_and_b32 v9, 0xffff0000, v2
    v_cvt_pk_bf16_f32 v2, v10, v11
    v_lshlrev_b32 v10, 16, v2
    v_and_b32 v11, 0xffff0000, v2
    v_add_f32 v10, 1.0, v10
    v_add_f32 v11, 1.0, v11
    v_cvt_pk_bf16_f32 v2, v10, v11
    v_lshlrev_b32 v10, 16, v2
    v_and_b32 v11, 0xffff0000, v2
    v_mul_f32 v28, v28, v10
    v_mul_f32 v29, v29, v11
    v_cvt_pk_bf16_f32 v2, v28, v29
    v_lshlrev_b32 v28, 16, v2
    v_and_b32 v29, 0xffff0000, v2
    v_add_f32 v28, v28, v8
    v_add_f32 v29, v29, v9
    v_cvt_pk_bf16_f32 v8, v28, v28
    v_cvt_pk_bf16_f32 v9, v29, v29
    s_nop 0
    v_and_b32_dpp v16, v8, v164 row_newbcast:0 row_mask:0xf bank_mask:0xf
    v_and_b32_dpp v17, v8, v165 row_newbcast:0 row_mask:0xf bank_mask:0xf
    v_and_b32_dpp v18, v8, v166 row_newbcast:0 row_mask:0xf bank_mask:0xf
    v_and_b32_dpp v19, v8, v167 row_newbcast:0 row_mask:0xf bank_mask:0xf
    s_nop 1
    v_mfma_f32_16x16x32_bf16 v[160:163], v[32:35], v[16:19], 0
    v_and_b32_dpp v20, v8, v164 row_newbcast:1 row_mask:0xf bank_mask:0xf
    v_and_b32_dpp v21, v8, v165 row_newbcast:1 row_mask:0xf bank_mask:0xf
    v_and_b32_dpp v22, v8, v166 row_newbcast:1 row_mask:0xf bank_mask:0xf
    v_and_b32_dpp v23, v8, v167 row_newbcast:1 row_mask:0xf bank_mask:0xf
    s_nop 1
    v_mfma_f32_16x16x32_bf16 v[160:163], v[36:39], v[20:23], v[160:163]
    v_and_b32_dpp v16, v8, v164 row_newbcast:2 row_mask:0xf bank_mask:0xf
    v_and_b32_dpp v17, v8, v165 row_newbcast:2 row_mask:0xf bank_mask:0xf
    v_and_b32_dpp v18, v8, v166 row_newbcast:2 row_mask:0xf bank_mask:0xf
    v_and_b32_dpp v19, v8, v167 row_newbcast:2 row_mask:0xf bank_mask:0xf
    s_nop 1
    v_mfma_f32_16x16x32_bf16 v[160:163], v[40:43], v[16:19], v[160:163]
    v_and_b32_dpp v20, v8, v164 row_newbcast:3 row_mask:0xf bank_mask:0xf
    v_and_b32_dpp v21, v8, v165 row_newbcast:3 row_mask:0xf bank_mask:0xf
    v_and_b32_dpp v22, v8, v166 row_newbcast:3 row_mask:0xf bank_mask:0xf
    v_and_b32_dpp v23, v8, v167 row_newbcast:3 row_mask:0xf bank_mask:0xf
    s_nop 1
    v_mfma_f32_16x16x32_bf16 v[160:163], v[44:47], v[20:23], v[160:163]
    v_and_b32_dpp v16, v8, v164 row_newbcast:4 row_mask:0xf bank_mask:0xf
    v_and_b32_dpp v17, v8, v165 row_newbcast:4 row_mask:0xf bank_mask:0xf
    v_and_b32_dpp v18, v8, v166 row_newbcast:4 row_mask:0xf bank_mask:0xf
    v_and_b32_dpp v19, v8, v167 row_newbcast:4 row_mask:0xf bank_mask:0xf
    s_nop 1
    v_mfma_f32_16x16x32_bf16 v[160:163], v[48:51], v[16:19], v[160:163]
    v_and_b32_dpp v20, v8, v164 row_newbcast:5 row_mask:0xf bank_mask:0xf
    v_and_b32_dpp v21, v8, v165 row_newbcast:5 row_mask:0xf bank_mask:0xf
    v_and_b32_dpp v22, v8, v166 row_newbcast:5 row_mask:0xf bank_mask:0xf
    v_and_b32_dpp v23, v8, v167 row_newbcast:5 row_mask:0xf bank_mask:0xf
    s_nop 1
    v_mfma_f32_16x16x32_bf16 v[160:163], v[52:55], v[20:23], v[160:163]
    v_and_b32_dpp v16, v8, v164 row_newbcast:6 row_mask:0xf bank_mask:0xf
    v_and_b32_dpp v17, v8, v165 row_newbcast:6 row_mask:0xf bank_mask:0xf
    v_and_b32_dpp v18, v8, v166 row_newbcast:6 row_mask:0xf bank_mask:0xf
    v_and_b32_dpp v19, v8, v167 row_newbcast:6 row_mask:0xf bank_mask:0xf
    s_nop 1
    v_mfma_f32_16x16x32_bf16 v[160:163], v[56:59], v[16:19], v[160:163]
    v_and_b32_dpp v20, v8, v164 row_newbcast:7 row_mask:0xf bank_mask:0xf
    v_and_b32_dpp v21, v8, v165 row_newbcast:7 row_mask:0xf bank_mask:0xf
    v_and_b32_dpp v22, v8, v166 row_newbcast:7 row_mask:0xf bank_mask:0xf
    v_and_b32_dpp v23, v8, v167 row_newbcast:7 row_mask:0xf bank_mask:0xf
    s_nop 1
    v_mfma_f32_16x16x32_bf16 v[160:163], v[60:63], v[20:23], v[160:163]
    v_and_b32_dpp v16, v8, v164 row_newbcast:8 row_mask:0xf bank_mask:0xf
    v_and_b32_dpp v17, v8, v165 row_newbcast:8 row_mask:0xf bank_mask:0xf
    v_and_b32_dpp v18, v8, v166 row_newbcast:8 row_mask:0xf bank_mask:0xf
    v_and_b32_dpp v19, v8, v167 row_newbcast:8 row_mask:0xf bank_mask:0xf
    s_nop 1
    v_mfma_f32_16x16x32_bf16 v[160:163], v[64:67], v[16:19], v[160:163]
    v_and_b32_dpp v20, v8, v164 row_newbcast:9 row_mask:0xf bank_mask:0xf
    v_and_b32_dpp v21, v8, v165 row_newbcast:9 row_mask:0xf bank_mask:0xf
    v_and_b32_dpp v22, v8, v166 row_newbcast:9 row_mask:0xf bank_mask:0xf
    v_and_b32_dpp v23, v8, v167 row_newbcast:9 row_mask:0xf bank_mask:0xf
    s_nop 1
    v_mfma_f32_16x16x32_bf16 v[160:163], v[68:71], v[20:23], v[160:163]
    v_and_b32_dpp v16, v8, v164 row_newbcast:10 row_mask:0xf bank_mask:0xf
    v_and_b32_dpp v17, v8, v165 row_newbcast:10 row_mask:0xf bank_mask:0xf
    v_and_b32_dpp v18, v8, v166 row_newbcast:10 row_mask:0xf bank_mask:0xf
    v_and_b32_dpp v19, v8, v167 row_newbcast:10 row_mask:0xf bank_mask:0xf
    s_nop 1
    v_mfma_f32_16x16x32_bf16 v[160:163], v[72:75], v[16:19], v[160:163]
    v_and_b32_dpp v20, v8, v164 row_newbcast:11 row_mask:0xf bank_mask:0xf
    v_and_b32_dpp v21, v8, v165 row_newbcast:11 row_mask:0xf bank_mask:0xf
    v_and_b32_dpp v22, v8, v166 row_newbcast:11 row_mask:0xf bank_mask:0xf
    v_and_b32_dpp v23, v8, v167 row_newbcast:11 row_mask:0xf bank_mask:0xf
    s_nop 1
    v_mfma_f32_16x16x32_bf16 v[160:163], v[76:79], v[20:23], v[160:163]
    v_and_b32_dpp v16, v8, v164 row_newbcast:12 row_mask:0xf bank_mask:0xf
    v_and_b32_dpp v17, v8, v165 row_newbcast:12 row_mask:0xf bank_mask:0xf
    v_and_b32_dpp v18, v8, v166 row_newbcast:12 row_mask:0xf bank_mask:0xf
    v_and_b32_dpp v19, v8, v167 row_newbcast:12 row_mask:0xf bank_mask:0xf
    s_nop 1
    v_mfma_f32_16x16x32_bf16 v[160:163], v[80:83], v[16:19], v[160:163]
    v_and_b32_dpp v20, v8, v164 row_newbcast:13 row_mask:0xf bank_mask:0xf
    v_and_b32_dpp v21, v8, v165 row_newbcast:13 row_mask:0xf bank_mask:0xf
    v_and_b32_dpp v22, v8, v166 row_newbcast:13 row_mask:0xf bank_mask:0xf
    v_and_b32_dpp v23, v8, v167 row_newbcast:13 row_mask:0xf bank_mask:0xf
    s_nop 1
    v_mfma_f32_16x16x32_bf16 v[160:163], v[84:87], v[20:23], v[160:163]
    v_and_b32_dpp v16, v8, v164 row_newbcast:14 row_mask:0xf bank_mask:0xf
    v_and_b32_dpp v17, v8, v165 row_newbcast:14 row_mask:0xf bank_mask:0xf
    v_and_b32_dpp v18, v8, v166 row_newbcast:14 row_mask:0xf bank_mask:0xf
    v_and_b32_dpp v19, v8, v167 row_newbcast:14 row_mask:0xf bank_mask:0xf
    s_nop 1
    v_mfma_f32_16x16x32_bf16 v[160:163], v[88:91], v[16:19], v[160:163]
    v_and_b32_dpp v20, v8, v164 row_newbcast:15 row_mask:0xf bank_mask:0xf
    v_and_b32_dpp v21, v8, v165 row_newbcast:15 row_mask:0xf bank_mask:0xf
    v_and_b32_dpp v22, v8, v166 row_newbcast:15 row_mask:0xf bank_mask:0xf
    v_and_b32_dpp v23, v8, v167 row_newbcast:15 row_mask:0xf bank_mask:0xf
    s_nop 1
    v_mfma_f32_16x16x32_bf16 v[160:163], v[92:95], v[20:23], v[160:163]
    v_and_b32_dpp v16, v9, v164 row_newbcast:0 row_mask:0xf bank_mask:0xf
    v_and_b32_dpp v17, v9, v165 row_newbcast:0 row_mask:0xf bank_mask:0xf
    v_and_b32_dpp v18, v9, v166 row_newbcast:0 row_mask:0xf bank_mask:0xf
    v_and_b32_dpp v19, v9, v167 row_newbcast:0 row_mask:0xf bank_mask:0xf
    s_nop 1
    v_mfma_f32_16x16x32_bf16 v[160:163], v[96:99], v[16:19], v[160:163]
    v_and_b32_dpp v20, v9, v164 row_newbcast:1 row_mask:0xf bank_mask:0xf
    v_and_b32_dpp v21, v9, v165 row_newbcast:1 row_mask:0xf bank_mask:0xf
    v_and_b32_dpp v22, v9, v166 row_newbcast:1 row_mask:0xf bank_mask:0xf
    v_and_b32_dpp v23, v9, v167 row_newbcast:1 row_mask:0xf bank_mask:0xf
    s_nop 1
    v_mfma_f32_16x16x32_bf16 v[160:163], v[100:103], v[20:23], v[160:163]
    v_and_b32_dpp v16, v9, v164 row_newbcast:2 row_mask:0xf bank_mask:0xf
    v_and_b32_dpp v17, v9, v165 row_newbcast:2 row_mask:0xf bank_mask:0xf
    v_and_b32_dpp v18, v9, v166 row_newbcast:2 row_mask:0xf bank_mask:0xf
    v_and_b32_dpp v19, v9, v167 row_newbcast:2 row_mask:0xf bank_mask:0xf
    s_nop 1
    v_mfma_f32_16x16x32_bf16 v[160:163], v[104:107], v[16:19], v[160:163]
    v_and_b32_dpp v20, v9, v164 row_newbcast:3 row_mask:0xf bank_mask:0xf
    v_and_b32_dpp v21, v9, v165 row_newbcast:3 row_mask:0xf bank_mask:0xf
    v_and_b32_dpp v22, v9, v166 row_newbcast:3 row_mask:0xf bank_mask:0xf
    v_and_b32_dpp v23, v9, v167 row_newbcast:3 row_mask:0xf bank_mask:0xf
    s_nop 1
    v_mfma_f32_16x16x32_bf16 v[160:163], v[108:111], v[20:23], v[160:163]
    v_and_b32_dpp v16, v9, v164 row_newbcast:4 row_mask:0xf bank_mask:0xf
    v_and_b32_dpp v17, v9, v165 row_newbcast:4 row_mask:0xf bank_mask:0xf
    v_and_b32_dpp v18, v9, v166 row_newbcast:4 row_mask:0xf bank_mask:0xf
    v_and_b32_dpp v19, v9, v167 row_newbcast:4 row_mask:0xf bank_mask:0xf
    s_nop 1
    v_mfma_f32_16x16x32_bf16 v[160:163], v[112:115], v[16:19], v[160:163]
    v_and_b32_dpp v20, v9, v164 row_newbcast:5 row_mask:0xf bank_mask:0xf
    v_and_b32_dpp v21, v9, v165 row_newbcast:5 row_mask:0xf bank_mask:0xf
    v_and_b32_dpp v22, v9, v166 row_newbcast:5 row_mask:0xf bank_mask:0xf
    v_and_b32_dpp v23, v9, v167 row_newbcast:5 row_mask:0xf bank_mask:0xf
    s_nop 1
    v_mfma_f32_16x16x32_bf16 v[160:163], v[116:119], v[20:23], v[160:163]
    v_and_b32_dpp v16, v9, v164 row_newbcast:6 row_mask:0xf bank_mask:0xf
    v_and_b32_dpp v17, v9, v165 row_newbcast:6 row_mask:0xf bank_mask:0xf
    v_and_b32_dpp v18, v9, v166 row_newbcast:6 row_mask:0xf bank_mask:0xf
    v_and_b32_dpp v19, v9, v167 row_newbcast:6 row_mask:0xf bank_mask:0xf
    s_nop 1
    v_mfma_f32_16x16x32_bf16 v[160:163], v[120:123], v[16:19], v[160:163]
    v_and_b32_dpp v20, v9, v164 row_newbcast:7 row_mask:0xf bank_mask:0xf
    v_and_b32_dpp v21, v9, v165 row_newbcast:7 row_mask:0xf bank_mask:0xf
    v_and_b32_dpp v22, v9, v166 row_newbcast:7 row_mask:0xf bank_mask:0xf
    v_and_b32_dpp v23, v9, v167 row_newbcast:7 row_mask:0xf bank_mask:0xf
    s_nop 1
    v_mfma_f32_16x16x32_bf16 v[160:163], v[124:127], v[20:23], v[160:163]
    v_and_b32_dpp v16, v9, v164 row_newbcast:8 row_mask:0xf bank_mask:0xf
    v_and_b32_dpp v17, v9, v165 row_newbcast:8 row_mask:0xf bank_mask:0xf
    v_and_b32_dpp v18, v9, v166 row_newbcast:8 row_mask:0xf bank_mask:0xf
    v_and_b32_dpp v19, v9, v167 row_newbcast:8 row_mask:0xf bank_mask:0xf
    s_nop 1
    v_mfma_f32_16x16x32_bf16 v[160:163], v[128:131], v[16:19], v[160:163]
    v_and_b32_dpp v20, v9, v164 row_newbcast:9 row_mask:0xf bank_mask:0xf
    v_and_b32_dpp v21, v9, v165 row_newbcast:9 row_mask:0xf bank_mask:0xf
    v_and_b32_dpp v22, v9, v166 row_newbcast:9 row_mask:0xf bank_mask:0xf
    v_and_b32_dpp v23, v9, v167 row_newbcast:9 row_mask:0xf bank_mask:0xf
    s_nop 1
    v_mfma_f32_16x16x32_bf16 v[160:163], v[132:135], v[20:23], v[160:163]
    v_and_b32_dpp v16, v9, v164 row_newbcast:10 row_mask:0xf bank_mask:0xf
    v_and_b32_dpp v17, v9, v165 row_newbcast:10 row_mask:0xf bank_mask:0xf
    v_and_b32_dpp v18, v9, v166 row_newbcast:10 row_mask:0xf bank_mask:0xf
    v_and_b32_dpp v19, v9, v167 row_newbcast:10 row_mask:0xf bank_mask:0xf
    s_nop 1
    v_mfma_f32_16x16x32_bf16 v[160:163], v[136:139], v[16:19], v[160:163]
    v_and_b32_dpp v20, v9, v164 row_newbcast:11 row_mask:0xf bank_mask:0xf
    v_and_b32_dpp v21, v9, v165 row_newbcast:11 row_mask:0xf bank_mask:0xf
    v_and_b32_dpp v22, v9, v166 row_newbcast:11 row_mask:0xf bank_mask:0xf
    v_and_b32_dpp v23, v9, v167 row_newbcast:11 row_mask:0xf bank_mask:0xf
    s_nop 1
    v_mfma_f32_16x16x32_bf16 v[160:163], v[140:143], v[20:23], v[160:163]
    v_and_b32_dpp v16, v9, v164 row_newbcast:12 row_mask:0xf bank_mask:0xf
    v_and_b32_dpp v17, v9, v165 row_newbcast:12 row_mask:0xf bank_mask:0xf
    v_and_b32_dpp v18, v9, v166 row_newbcast:12 row_mask:0xf bank_mask:0xf
    v_and_b32_dpp v19, v9, v167 row_newbcast:12 row_mask:0xf bank_mask:0xf
    s_nop 1
    v_mfma_f32_16x16x32_bf16 v[160:163], v[144:147], v[16:19], v[160:163]
    v_and_b32_dpp v20, v9, v164 row_newbcast:13 row_mask:0xf bank_mask:0xf
    v_and_b32_dpp v21, v9, v165 row_newbcast:13 row_mask:0xf bank_mask:0xf
    v_and_b32_dpp v22, v9, v166 row_newbcast:13 row_mask:0xf bank_mask:0xf
    v_and_b32_dpp v23, v9, v167 row_newbcast:13 row_mask:0xf bank_mask:0xf
    s_nop 1
    v_mfma_f32_16x16x32_bf16 v[160:163], v[148:151], v[20:23], v[160:163]
    v_and_b32_dpp v16, v9, v164 row_newbcast:14 row_mask:0xf bank_mask:0xf
    v_and_b32_dpp v17, v9, v165 row_newbcast:14 row_mask:0xf bank_mask:0xf
    v_and_b32_dpp v18, v9, v166 row_newbcast:14 row_mask:0xf bank_mask:0xf
    v_and_b32_dpp v19, v9, v167 row_newbcast:14 row_mask:0xf bank_mask:0xf
    s_nop 1
    v_mfma_f32_16x16x32_bf16 v[160:163], v[152:155], v[16:19], v[160:163]
    v_and_b32_dpp v20, v9, v164 row_newbcast:15 row_mask:0xf bank_mask:0xf
    v_and_b32_dpp v21, v9, v165 row_newbcast:15 row_mask:0xf bank_mask:0xf
    v_and_b32_dpp v22, v9, v166 row_newbcast:15 row_mask:0xf bank_mask:0xf
    v_and_b32_dpp v23, v9, v167 row_newbcast:15 row_mask:0xf bank_mask:0xf
    s_nop 1
    v_mfma_f32_16x16x32_bf16 v[160:163], v[156:159], v[20:23], v[160:163]
    s_lshl_b32 s8, s4, 9
    s_add_u32 s8, s8, 115200
    v_lshrrev_b32 v2, 4, v0
    v_lshlrev_b32 v2, 7, v2
    v_and_b32 v3, 15, v0
    v_lshl_add_u32 v2, v3, 2, v2
    v_add_u32 v2, s8, v2
    s_mov_b32 exec_lo, 0x00ff00ff
    s_mov_b32 exec_hi, 0x00ff00ff
    ds_write_b32 v2, v160 offset:0
    ds_write_b32 v2, v161 offset:32
    ds_write_b32 v2, v162 offset:64
    ds_write_b32 v2, v163 offset:96
    s_mov_b64 exec, -1
    s_waitcnt lgkmcnt(0)
    s_barrier
    s_cmp_lg_u32 s4, 1
    s_cbranch_scc1 H_NOCLR
    s_cmp_ge_u32 s2, 192
    s_cbranch_scc1 H_NOCLR
    s_cmp_lt_u32 s2, 64
    s_cselect_b32 s8, 0, -1
    v_mov_b32 v4, s8
    v_mov_b32 v5, s8
    v_mov_b32 v6, s8
    v_mov_b32 v7, s8
    s_lshl_b32 s9, s2, 7
    s_add_u32 s9, s9, 262144
    v_lshlrev_b32 v2, 4, v0
    s_mov_b64 exec, 0xff
    buffer_store_dwordx4 v[4:7], v2, s[56:59], s9 offen sc1
    s_mov_b64 exec, 1
    v_mov_b32 v2, 1
    v_mov_b32 v3, 132
    s_waitcnt vmcnt(0)
    buffer_atomic_add v2, v3, s[64:67], 0 offen sc1
    s_mov_b64 exec, -1
H_NOCLR:
    s_mov_b32 s12, 0
    s_sub_u32 s13, s2, 96
    s_cmp_lt_u32 s13, 56
    s_cbranch_scc1 H_PREP2
    s_sub_u32 s13, s2, 160
    s_cmp_lt_u32 s13, 16
    s_cbranch_scc1 H_PREP3
    s_branch H_ST
H_PREP2:
    s_mov_b32 s12, 1
    s_cmp_lt_u32 s4, 2
    s_cselect_b32 s52, s28, s30
    s_cselect_b32 s53, s29, s31
    s_mov_b32 s54, 1835008
    s_mov_b32 s55, 0x00020000
    v_lshrrev_b32 v2, 4, v0
    s_mov_b32 s10, 28672
    v_mul_lo_u32 v2, v2, s10
    v_and_b32 v3, 15, v0
    v_lshl_add_u32 v30, v3, 2, v2
    s_and_b32 s14, s4, 1
    s_mul_i32 s14, s14, 917504
    s_lshl_b32 s9, s13, 6
    s_add_u32 s14, s14, s9
    s_lshl_b32 s9, s4, 14
    v_lshlrev_b32 v3, 4, v0
    v_add_u32 v31, s9, v3
    s_mov_b32 s10, 0x05040100
    s_mov_b32 s11, 0x07060302
    s_waitcnt vmcnt(3)
    buffer_load_dword v32, v30, s[52:55], s14 offen
    s_add_u32 s14, s14, 3584
    s_waitcnt vmcnt(3)
    buffer_load_dword v33, v30, s[52:55], s14 offen
    s_add_u32 s14, s14, 3584
    s_waitcnt vmcnt(3)
    buffer_load_dword v34, v30, s[52:55], s14 offen
    s_add_u32 s14, s14, 3584
    s_waitcnt vmcnt(3)
    buffer_load_dword v35, v30, s[52:55], s14 offen
    s_add_u32 s14, s14, 3584
    s_waitcnt vmcnt(3)
    buffer_load_dword v36, v30, s[52:55], s14 offen
    s_add_u32 s14, s14, 3584
    s_waitcnt vmcnt(3)
    buffer_load_dword v37, v30, s[52:55], s14 offen
    s_add_u32 s14, s14, 3584
    s_waitcnt vmcnt(3)
    buffer_load_dword v38, v30, s[52:55], s14 offen
    s_add_u32 s14, s14, 3584
    s_waitcnt vmcnt(3)
    buffer_load_dword v39, v30, s[52:55], s14 offen
    s_add_u32 s14, s14, 89600
    s_waitcnt vmcnt(3)
    buffer_load_dword v40, v30, s[52:55], s14 offen
    s_add_u32 s14, s14, 3584
    s_waitcnt vmcnt(3)
    buffer_load_dword v41, v30, s[52:55], s14 offen
    s_add_u32 s14, s14, 3584
    s_waitcnt vmcnt(3)
    buffer_load_dword v42, v30, s[52:55], s14 offen
    s_add_u32 s14, s14, 3584
    s_waitcnt vmcnt(3)
    buffer_load_dword v43, v30, s[52:55], s14 offen
    s_add_u32 s14, s14, 3584
    s_waitcnt vmcnt(3)
    buffer_load_dword v44, v30, s[52:55], s14 offen
    s_add_u32 s14, s14, 3584
    s_waitcnt vmcnt(3)
    buffer_load_dword v45, v30, s[52:55], s14 offen
    s_add_u32 s14, s14, 3584
    s_waitcnt vmcnt(3)
    buffer_load_dword v46, v30, s[52:55], s14 offen
    s_add_u32 s14, s14, 3584
    s_waitcnt vmcnt(3)
    buffer_load_dword v47, v30, s[52:55], s14 offen
    s_add_u32 s14, s14, 89600
    v_perm_b32 v144, v33, v32, s10
    v_perm_b32 v148, v33, v32, s11
    v_perm_b32 v145, v35, v34, s10
    v_perm_b32 v149, v35, v34, s11
    v_perm_b32 v146, v37, v36, s10
    v_perm_b32 v150, v37, v36, s11
    v_perm_b32 v147, v39, v38, s10
    v_perm_b32 v151, v39, v38, s11
    ds_write_b128 v31, v[144:147] offset:0
    ds_write_b128 v31, v[148:151] offset:1024
    s_waitcnt vmcnt(3)
    buffer_load_dword v32, v30, s[52:55], s14 offen
    s_add_u32 s14, s14, 3584
    s_waitcnt vmcnt(3)
    buffer_load_dword v33, v30, s[52:55], s14 offen
    s_add_u32 s14, s14, 3584
    s_waitcnt vmcnt(3)
    buffer_load_dword v34, v30, s[52:55], s14 offen
    s_add_u32 s14, s14, 3584
    s_waitcnt vmcnt(3)
    buffer_load_dword v35, v30, s[52:55], s14 offen
    s_add_u32 s14, s14, 3584
    s_waitcnt vmcnt(3)
    buffer_load_dword v36, v30, s[52:55], s14 offen
    s_add_u32 s14, s14, 3584
    s_waitcnt vmcnt(3)
    buffer_load_dword v37, v30, s[52:55], s14 offen
    s_add_u32 s14, s14, 3584
    s_waitcnt vmcnt(3)
    buffer_load_dword v38, v30, s[52:55], s14 offen
    s_add_u32 s14, s14, 3584
    s_waitcnt vmcnt(3)
    buffer_load_dword v39, v30, s[52:55], s14 offen
    s_add_u32 s14, s14, 89600
    v_perm_b32 v152, v41, v40, s10
    v_perm_b32 v156, v41, v40, s11
    v_perm_b32 v153, v43, v42, s10
    v_perm_b32 v157, v43, v42, s11
    v_perm_b32 v154, v45, v44, s10
    v_perm_b32 v158, v45, v44, s11
    v_perm_b32 v155, v47, v46, s10
    v_perm_b32 v159, v47, v46, s11
    ds_write_b128 v31, v[152:155] offset:2048
    ds_write_b128 v31, v[156:159] offset:3072
    s_waitcnt vmcnt(3)
    buffer_load_dword v40, v30, s[52:55], s14 offen
    s_add_u32 s14, s14, 3584
    s_waitcnt vmcnt(3)
    buffer_load_dword v41, v30, s[52:55], s14 offen
    s_add_u32 s14, s14, 3584
    s_waitcnt vmcnt(3)
    buffer_load_dword v42, v30, s[52:55], s14 offen
    s_add_u32 s14, s14, 3584
    s_waitcnt vmcnt(3)
    buffer_load_dword v43, v30, s[52:55], s14 offen
    s_add_u32 s14, s14, 3584
    s_waitcnt vmcnt(3)
    buffer_load_dword v44, v30, s[52:55], s14 offen
    s_add_u32 s14, s14, 3584
    s_waitcnt vmcnt(3)
    buffer_load_dword v45, v30, s[52:55], s14 offen
    s_add_u32 s14, s14, 3584
    s_waitcnt vmcnt(3)
    buffer_load_dword v46, v30, s[52:55], s14 offen
    s_add_u32 s14, s14, 3584
    s_waitcnt vmcnt(3)
    buffer_load_dword v47, v30, s[52:55], s14 offen
    s_add_u32 s14, s14, 89600
    v_perm_b32 v144, v33, v32, s10
    v_perm_b32 v148, v33, v32, s11
    v_perm_b32 v145, v35, v34, s10
    v_perm_b32 v149, v35, v34, s11
    v_perm_b32 v146, v37, v36, s10
    v_perm_b32 v150, v37, v36, s11
    v_perm_b32 v147, v39, v38, s10
    v_perm_b32 v151, v39, v38, s11
    ds_write_b128 v31, v[144:147] offset:4096
    ds_write_b128 v31, v[148:151] offset:5120
    s_waitcnt vmcnt(3)
    buffer_load_dword v32, v30, s[52:55], s14 offen
    s_add_u32 s14, s14, 3584
    s_waitcnt vmcnt(3)
    buffer_load_dword v33, v30, s[52:55], s14 offen
    s_add_u32 s14, s14, 3584
    s_waitcnt vmcnt(3)
    buffer_load_dword v34, v30, s[52:55], s14 offen
    s_add_u32 s14, s14, 3584
    s_waitcnt vmcnt(3)
    buffer_load_dword v35, v30, s[52:55], s14 offen
    s_add_u32 s14, s14, 3584
    s_waitcnt vmcnt(3)
    buffer_load_dword v36, v30, s[52:55], s14 offen
    s_add_u32 s14, s14, 3584
    s_waitcnt vmcnt(3)
    buffer_load_dword v37, v30, s[52:55], s14 offen
    s_add_u32 s14, s14, 3584
    s_waitcnt vmcnt(3)
    buffer_load_dword v38, v30, s[52:55], s14 offen
    s_add_u32 s14, s14, 3584
    s_waitcnt vmcnt(3)
    buffer_load_dword v39, v30, s[52:55], s14 offen
    s_add_u32 s14, s14, 89600
    v_perm_b32 v152, v41, v40, s10
    v_perm_b32 v156, v41, v40, s11
    v_perm_b32 v153, v43, v42, s10
    v_perm_b32 v157, v43, v42, s11
    v_perm_b32 v154, v45, v44, s10
    v_perm_b32 v158, v45, v44, s11
    v_perm_b32 v155, v47, v46, s10
    v_perm_b32 v159, v47, v46, s11
    ds_write_b128 v31, v[152:155] offset:6144
    ds_write_b128 v31, v[156:159] offset:7168
    s_waitcnt vmcnt(3)
    buffer_load_dword v40, v30, s[52:55], s14 offen
    s_add_u32 s14, s14, 3584
    s_waitcnt vmcnt(3)
    buffer_load_dword v41, v30, s[52:55], s14 offen
    s_add_u32 s14, s14, 3584
    s_waitcnt vmcnt(3)
    buffer_load_dword v42, v30, s[52:55], s14 offen
    s_add_u32 s14, s14, 3584
    s_waitcnt vmcnt(3)
    buffer_load_dword v43, v30, s[52:55], s14 offen
    s_add_u32 s14, s14, 3584
    s_waitcnt vmcnt(3)
    buffer_load_dword v44, v30, s[52:55], s14 offen
    s_add_u32 s14, s14, 3584
    s_waitcnt vmcnt(3)
    buffer_load_dword v45, v30, s[52:55], s14 offen
    s_add_u32 s14, s14, 3584
    s_waitcnt vmcnt(3)
    buffer_load_dword v46, v30, s[52:55], s14 offen
    s_add_u32 s14, s14, 3584
    s_waitcnt vmcnt(3)
    buffer_load_dword v47, v30, s[52:55], s14 offen
    s_add_u32 s14, s14, 89600
    v_perm_b32 v144, v33, v32, s10
    v_perm_b32 v148, v33, v32, s11
    v_perm_b32 v145, v35, v34, s10
    v_perm_b32 v149, v35, v34, s11
    v_perm_b32 v146, v37, v36, s10
    v_perm_b32 v150, v37, v36, s11
    v_perm_b32 v147, v39, v38, s10
    v_perm_b32 v151, v39, v38, s11
    ds_write_b128 v31, v[144:147] offset:8192
    ds_write_b128 v31, v[148:151] offset:9216
    s_waitcnt vmcnt(3)
    buffer_load_dword v32, v30, s[52:55], s14 offen
    s_add_u32 s14, s14, 3584
    s_waitcnt vmcnt(3)
    buffer_load_dword v33, v30, s[52:55], s14 offen
    s_add_u32 s14, s14, 3584
    s_waitcnt vmcnt(3)
    buffer_load_dword v34, v30, s[52:55], s14 offen
    s_add_u32 s14, s14, 3584
    s_waitcnt vmcnt(3)
    buffer_load_dword v35, v30, s[52:55], s14 offen
    s_add_u32 s14, s14, 3584
    s_waitcnt vmcnt(3)
    buffer_load_dword v36, v30, s[52:55], s14 offen
    s_add_u32 s14, s14, 3584
    s_waitcnt vmcnt(3)
    buffer_load_dword v37, v30, s[52:55], s14 offen
    s_add_u32 s14, s14, 3584
    s_waitcnt vmcnt(3)
    buffer_load_dword v38, v30, s[52:55], s14 offen
    s_add_u32 s14, s14, 3584
    s_waitcnt vmcnt(3)
    buffer_load_dword v39, v30, s[52:55], s14 offen
    s_add_u32 s14, s14, 89600
    v_perm_b32 v152, v41, v40, s10
    v_perm_b32 v156, v41, v40, s11
    v_perm_b32 v153, v43, v42, s10
    v_perm_b32 v157, v43, v42, s11
    v_perm_b32 v154, v45, v44, s10
    v_perm_b32 v158, v45, v44, s11
    v_perm_b32 v155, v47, v46, s10
    v_perm_b32 v159, v47, v46, s11
    ds_write_b128 v31, v[152:155] offset:10240
    ds_write_b128 v31, v[156:159] offset:11264
    s_waitcnt vmcnt(3)
    buffer_load_dword v40, v30, s[52:55], s14 offen
    s_add_u32 s14, s14, 3584
    s_waitcnt vmcnt(3)
    buffer_load_dword v41, v30, s[52:55], s14 offen
    s_add_u32 s14, s14, 3584
    s_waitcnt vmcnt(3)
    buffer_load_dword v42, v30, s[52:55], s14 offen
    s_add_u32 s14, s14, 3584
    s_waitcnt vmcnt(3)
    buffer_load_dword v43, v30, s[52:55], s14 offen
    s_add_u32 s14, s14, 3584
    s_waitcnt vmcnt(3)
    buffer_load_dword v44, v30, s[52:55], s14 offen
    s_add_u32 s14, s14, 3584
    s_waitcnt vmcnt(3)
    buffer_load_dword v45, v30, s[52:55], s14 offen
    s_add_u32 s14, s14, 3584
    s_waitcnt vmcnt(3)
    buffer_load_dword v46, v30, s[52:55], s14 offen
    s_add_u32 s14, s14, 3584
    s_waitcnt vmcnt(3)
    buffer_load_dword v47, v30, s[52:55], s14 offen
    s_add_u32 s14, s14, 89600
    v_perm_b32 v144, v33, v32, s10
    v_perm_b32 v148, v33, v32, s11
    v_perm_b32 v145, v35, v34, s10
    v_perm_b32 v149, v35, v34, s11
    v_perm_b32 v146, v37, v36, s10
    v_perm_b32 v150, v37, v36, s11
    v_perm_b32 v147, v39, v38, s10
    v_perm_b32 v151, v39, v38, s11
    ds_write_b128 v31, v[144:147] offset:12288
    ds_write_b128 v31, v[148:151] offset:13312
    s_waitcnt vmcnt(0)
    v_perm_b32 v152, v41, v40, s10
    v_perm_b32 v156, v41, v40, s11
    v_perm_b32 v153, v43, v42, s10
    v_perm_b32 v157, v43, v42, s11
    v_perm_b32 v154, v45, v44, s10
    v_perm_b32 v158, v45, v44, s11
    v_perm_b32 v155, v47, v46, s10
    v_perm_b32 v159, v47, v46, s11
    ds_write_b128 v31, v[152:155] offset:14336
    ds_write_b128 v31, v[156:159] offset:15360
    s_waitcnt lgkmcnt(0)
    v_mov_b32 v2, 0
    s_mov_b64 exec, 1
    s_mov_b32 s15, 16384
POLL_5:
    buffer_load_dword v4, v2, s[64:67], 0 offen offset:68 sc1
    s_waitcnt vmcnt(0)
    v_cmp_gt_u32 vcc, 64, v4
    s_nop 3
    s_cbranch_vccz PDONE_6
    s_sub_u32 s15, s15, 1
    s_cmp_eq_u32 s15, 0
    s_cbranch_scc1 PDONE_6
    s_sleep 2
    s_branch POLL_5
PDONE_6:
    s_mov_b64 exec, -1
    s_mul_i32 s8, s4, 12288
    s_lshl_b32 s9, s4, 10
    v_lshlrev_b32 v2, 5, v0
    v_lshlrev_b32 v3, 4, v0
    buffer_load_dwordx4 v[8:11], v3, s[68:71], s9 offen
    s_add_u32 s10, s8, 4096
    buffer_load_dwordx4 v[32:35], v2, s[56:59], s10 offen sc1
    buffer_load_dwordx4 v[36:39], v2, s[56:59], s10 offen offset:16 sc1
    s_add_u32 s10, s8, 6144
    buffer_load_dwordx4 v[40:43], v2, s[56:59], s10 offen sc1
    buffer_load_dwordx4 v[44:47], v2, s[56:59], s10 offen offset:16 sc1
    s_add_u32 s10, s8, 8192
    buffer_load_dwordx4 v[48:51], v2, s[56:59], s10 offen sc1
    buffer_load_dwordx4 v[52:55], v2, s[56:59], s10 offen offset:16 sc1
    s_add_u32 s10, s8, 53248
    buffer_load_dwordx4 v[56:59], v2, s[56:59], s10 offen sc1
    buffer_load_dwordx4 v[60:63], v2, s[56:59], s10 offen offset:16 sc1
    s_add_u32 s10, s8, 55296
    buffer_load_dwordx4 v[64:67], v2, s[56:59], s10 offen sc1
    buffer_load_dwordx4 v[68:71], v2, s[56:59], s10 offen offset:16 sc1
    s_add_u32 s10, s8, 57344
    buffer_load_dwordx4 v[72:75], v2, s[56:59], s10 offen sc1
    buffer_load_dwordx4 v[76:79], v2, s[56:59], s10 offen offset:16 sc1
    s_add_u32 s10, s8, 102400
    buffer_load_dwordx4 v[80:83], v2, s[56:59], s10 offen sc1
    buffer_load_dwordx4 v[84:87], v2, s[56:59], s10 offen offset:16 sc1
    s_add_u32 s10, s8, 104448
    buffer_load_dwordx4 v[88:91], v2, s[56:59], s10 offen sc1
    buffer_load_dwordx4 v[92:95], v2, s[56:59], s10 offen offset:16 sc1
    s_add_u32 s10, s8, 106496
    buffer_load_dwordx4 v[96:99], v2, s[56:59], s10 offen sc1
    buffer_load_dwordx4 v[100:103], v2, s[56:59], s10 offen offset:16 sc1
    s_add_u32 s10, s8, 151552
    buffer_load_dwordx4 v[104:107], v2, s[56:59], s10 offen sc1
    buffer_load_dwordx4 v[108:111], v2, s[56:59], s10 offen offset:16 sc1
    s_add_u32 s10, s8, 153600
    buffer_load_dwordx4 v[112:115], v2, s[56:59], s10 offen sc1
    buffer_load_dwordx4 v[116:119], v2, s[56:59], s10 offen offset:16 sc1
    s_add_u32 s10, s8, 155648
    buffer_load_dwordx4 v[120:123], v2, s[56:59], s10 offen sc1
    buffer_load_dwordx4 v[124:127], v2, s[56:59], s10 offen offset:16 sc1
    s_waitcnt vmcnt(0)
    v_add_f32 v32, v32, v56
    v_add_f32 v80, v80, v104
    v_add_f32 v33, v33, v57
    v_add_f32 v81, v81, v105
    v_add_f32 v34, v34, v58
    v_add_f32 v82, v82, v106
    v_add_f32 v35, v35, v59
    v_add_f32 v83, v83, v107
    v_add_f32 v36, v36, v60
    v_add_f32 v84, v84, v108
    v_add_f32 v37, v37, v61
    v_add_f32 v85, v85, v109
    v_add_f32 v38, v38, v62
    v_add_f32 v86, v86, v110
    v_add_f32 v39, v39, v63
    v_add_f32 v87, v87, v111
    v_add_f32 v40, v40, v64
    v_add_f32 v88, v88, v112
    v_add_f32 v41, v41, v65
    v_add_f32 v89, v89, v113
    v_add_f32 v42, v42, v66
    v_add_f32 v90, v90, v114
    v_add_f32 v43, v43, v67
    v_add_f32 v91, v91, v115
    v_add_f32 v44, v44, v68
    v_add_f32 v92, v92, v116
    v_add_f32 v45, v45, v69
    v_add_f32 v93, v93, v117
    v_add_f32 v46, v46, v70
    v_add_f32 v94, v94, v118
    v_add_f32 v47, v47, v71
    v_add_f32 v95, v95, v119
    v_add_f32 v48, v48, v72
    v_add_f32 v96, v96, v120
    v_add_f32 v49, v49, v73
    v_add_f32 v97, v97, v121
    v_add_f32 v50, v50, v74
    v_add_f32 v98, v98, v122
    v_add_f32 v51, v51, v75
    v_add_f32 v99, v99, v123
    v_add_f32 v52, v52, v76
    v_add_f32 v100, v100, v124
    v_add_f32 v53, v53, v77
    v_add_f32 v101, v101, v125
    v_add_f32 v54, v54, v78
    v_add_f32 v102, v102, v126
    v_add_f32 v55, v55, v79
    v_add_f32 v103, v103, v127
    v_add_f32 v32, v32, v80
    v_add_f32 v33, v33, v81
    v_add_f32 v34, v34, v82
    v_add_f32 v35, v35, v83
    v_add_f32 v36, v36, v84
    v_add_f32 v37, v37, v85
    v_add_f32 v38, v38, v86
    v_add_f32 v39, v39, v87
    v_add_f32 v40, v40, v88
    v_add_f32 v41, v41, v89
    v_add_f32 v42, v42, v90
    v_add_f32 v43, v43, v91
    v_add_f32 v44, v44, v92
    v_add_f32 v45, v45, v93
    v_add_f32 v46, v46, v94
    v_add_f32 v47, v47, v95
    v_add_f32 v48, v48, v96
    v_add_f32 v49, v49, v97
    v_add_f32 v50, v50, v98
    v_add_f32 v51, v51, v99
    v_add_f32 v52, v52, v100
    v_add_f32 v53, v53, v101
    v_add_f32 v54, v54, v102
    v_add_f32 v55, v55, v103
    v_cvt_pk_bf16_f32 v2, v48, v49
    v_lshlrev_b32 v48, 16, v2
    v_and_b32 v49, 0xffff0000, v2
    v_cvt_pk_bf16_f32 v2, v50, v51
    v_lshlrev_b32 v50, 16, v2
    v_and_b32 v51, 0xffff0000, v2
    v_cvt_pk_bf16_f32 v2, v52, v53
    v_lshlrev_b32 v52, 16, v2
    v_and_b32 v53, 0xffff0000, v2
    v_cvt_pk_bf16_f32 v2, v54, v55
    v_lshlrev_b32 v54, 16, v2
    v_and_b32 v55, 0xffff0000, v2
    v_add_f32 v48, 1.0, v48
    v_add_f32 v49, 1.0, v49
    v_add_f32 v50, 1.0, v50
    v_add_f32 v51, 1.0, v51
    v_add_f32 v52, 1.0, v52
    v_add_f32 v53, 1.0, v53
    v_add_f32 v54, 1.0, v54
    v_add_f32 v55, 1.0, v55
    v_cvt_pk_bf16_f32 v12, v32, v33
    v_cvt_pk_bf16_f32 v13, v34, v35
    v_cvt_pk_bf16_f32 v14, v36, v37
    v_cvt_pk_bf16_f32 v15, v38, v39
    v_cvt_pk_bf16_f32 v24, v40, v41
    v_cvt_pk_bf16_f32 v25, v42, v43
    v_cvt_pk_bf16_f32 v26, v44, v45
    v_cvt_pk_bf16_f32 v27, v46, v47
    v_cvt_pk_bf16_f32 v28, v48, v49
    v_cvt_pk_bf16_f32 v29, v50, v51
    v_cvt_pk_bf16_f32 v30, v52, v53
    v_cvt_pk_bf16_f32 v31, v54, v55
    s_nop 0
    s_branch H_ST
H_PREP3:
    s_mov_b32 s52, s32
    s_mov_b32 s53, s33
    s_mov_b32 s54, 1835008
    s_mov_b32 s55, 0x00020000
    s_mov_b32 s12, 2
    v_lshrrev_b32 v2, 4, v0
    v_lshlrev_b32 v2, 13, v2
    v_and_b32 v3, 15, v0
    v_lshl_add_u32 v30, v3, 2, v2
    s_mul_i32 s14, s4, 458752
    s_lshl_b32 s9, s13, 6
    s_add_u32 s14, s14, s9
    s_mul_i32 s9, s4, 28672
    v_lshlrev_b32 v3, 4, v0
    v_add_u32 v31, s9, v3
    s_mov_b32 s10, 0x05040100
    s_mov_b32 s11, 0x07060302
    s_waitcnt vmcnt(3)
    buffer_load_dword v32, v30, s[52:55], s14 offen
    s_add_u32 s14, s14, 1024
    s_waitcnt vmcnt(3)
    buffer_load_dword v33, v30, s[52:55], s14 offen
    s_add_u32 s14, s14, 1024
    s_waitcnt vmcnt(3)
    buffer_load_dword v34, v30, s[52:55], s14 offen
    s_add_u32 s14, s14, 1024
    s_waitcnt vmcnt(3)
    buffer_load_dword v35, v30, s[52:55], s14 offen
    s_add_u32 s14, s14, 1024
    s_waitcnt vmcnt(3)
    buffer_load_dword v36, v30, s[52:55], s14 offen
    s_add_u32 s14, s14, 1024
    s_waitcnt vmcnt(3)
    buffer_load_dword v37, v30, s[52:55], s14 offen
    s_add_u32 s14, s14, 1024
    s_waitcnt vmcnt(3)
    buffer_load_dword v38, v30, s[52:55], s14 offen
    s_add_u32 s14, s14, 1024
    s_waitcnt vmcnt(3)
    buffer_load_dword v39, v30, s[52:55], s14 offen
    s_add_u32 s14, s14, 25600
    s_waitcnt vmcnt(3)
    buffer_load_dword v40, v30, s[52:55], s14 offen
    s_add_u32 s14, s14, 1024
    s_waitcnt vmcnt(3)
    buffer_load_dword v41, v30, s[52:55], s14 offen
    s_add_u32 s14, s14, 1024
    s_waitcnt vmcnt(3)
    buffer_load_dword v42, v30, s[52:55], s14 offen
    s_add_u32 s14, s14, 1024
    s_waitcnt vmcnt(3)
    buffer_load_dword v43, v30, s[52:55], s14 offen
    s_add_u32 s14, s14, 1024
    s_waitcnt vmcnt(3)
    buffer_load_dword v44, v30, s[52:55], s14 offen
    s_add_u32 s14, s14, 1024
    s_waitcnt vmcnt(3)
    buffer_load_dword v45, v30, s[52:55], s14 offen
    s_add_u32 s14, s14, 1024
    s_waitcnt vmcnt(3)
    buffer_load_dword v46, v30, s[52:55], s14 offen
    s_add_u32 s14, s14, 1024
    s_waitcnt vmcnt(3)
    buffer_load_dword v47, v30, s[52:55], s14 offen
    s_add_u32 s14, s14, 25600
    v_perm_b32 v144, v33, v32, s10
    v_perm_b32 v148, v33, v32, s11
    v_perm_b32 v145, v35, v34, s10
    v_perm_b32 v149, v35, v34, s11
    v_perm_b32 v146, v37, v36, s10
    v_perm_b32 v150, v37, v36, s11
    v_perm_b32 v147, v39, v38, s10
    v_perm_b32 v151, v39, v38, s11
    ds_write_b128 v31, v[144:147] offset:0
    ds_write_b128 v31, v[148:151] offset:1024
    s_waitcnt vmcnt(3)
    buffer_load_dword v32, v30, s[52:55], s14 offen
    s_add_u32 s14, s14, 1024
    s_waitcnt vmcnt(3)
    buffer_load_dword v33, v30, s[52:55], s14 offen
    s_add_u32 s14, s14, 1024
    s_waitcnt vmcnt(3)
    buffer_load_dword v34, v30, s[52:55], s14 offen
    s_add_u32 s14, s14, 1024
    s_waitcnt vmcnt(3)
    buffer_load_dword v35, v30, s[52:55], s14 offen
    s_add_u32 s14, s14, 1024
    s_waitcnt vmcnt(3)
    buffer_load_dword v36, v30, s[52:55], s14 offen
    s_add_u32 s14, s14, 1024
    s_waitcnt vmcnt(3)
    buffer_load_dword v37, v30, s[52:55], s14 offen
    s_add_u32 s14, s14, 1024
    s_waitcnt vmcnt(3)
    buffer_load_dword v38, v30, s[52:55], s14 offen
    s_add_u32 s14, s14, 1024
    s_waitcnt vmcnt(3)
    buffer_load_dword v39, v30, s[52:55], s14 offen
    s_add_u32 s14, s14, 25600
    v_perm_b32 v152, v41, v40, s10
    v_perm_b32 v156, v41, v40, s11
    v_perm_b32 v153, v43, v42, s10
    v_perm_b32 v157, v43, v42, s11
    v_perm_b32 v154, v45, v44, s10
    v_perm_b32 v158, v45, v44, s11
    v_perm_b32 v155, v47, v46, s10
    v_perm_b32 v159, v47, v46, s11
    ds_write_b128 v31, v[152:155] offset:2048
    ds_write_b128 v31, v[156:159] offset:3072
    s_waitcnt vmcnt(3)
    buffer_load_dword v40, v30, s[52:55], s14 offen
    s_add_u32 s14, s14, 1024
    s_waitcnt vmcnt(3)
    buffer_load_dword v41, v30, s[52:55], s14 offen
    s_add_u32 s14, s14, 1024
    s_waitcnt vmcnt(3)
    buffer_load_dword v42, v30, s[52:55], s14 offen
    s_add_u32 s14, s14, 1024
    s_waitcnt vmcnt(3)
    buffer_load_dword v43, v30, s[52:55], s14 offen
    s_add_u32 s14, s14, 1024
    s_waitcnt vmcnt(3)
    buffer_load_dword v44, v30, s[52:55], s14 offen
    s_add_u32 s14, s14, 1024
    s_waitcnt vmcnt(3)
    buffer_load_dword v45, v30, s[52:55], s14 offen
    s_add_u32 s14, s14, 1024
    s_waitcnt vmcnt(3)
    buffer_load_dword v46, v30, s[52:55], s14 offen
    s_add_u32 s14, s14, 1024
    s_waitcnt vmcnt(3)
    buffer_load_dword v47, v30, s[52:55], s14 offen
    s_add_u32 s14, s14, 25600
    v_perm_b32 v144, v33, v32, s10
    v_perm_b32 v148, v33, v32, s11
    v_perm_b32 v145, v35, v34, s10
    v_perm_b32 v149, v35, v34, s11
    v_perm_b32 v146, v37, v36, s10
    v_perm_b32 v150, v37, v36, s11
    v_perm_b32 v147, v39, v38, s10
    v_perm_b32 v151, v39, v38, s11
    ds_write_b128 v31, v[144:147] offset:4096
    ds_write_b128 v31, v[148:151] offset:5120
    s_waitcnt vmcnt(3)
    buffer_load_dword v32, v30, s[52:55], s14 offen
    s_add_u32 s14, s14, 1024
    s_waitcnt vmcnt(3)
    buffer_load_dword v33, v30, s[52:55], s14 offen
    s_add_u32 s14, s14, 1024
    s_waitcnt vmcnt(3)
    buffer_load_dword v34, v30, s[52:55], s14 offen
    s_add_u32 s14, s14, 1024
    s_waitcnt vmcnt(3)
    buffer_load_dword v35, v30, s[52:55], s14 offen
    s_add_u32 s14, s14, 1024
    s_waitcnt vmcnt(3)
    buffer_load_dword v36, v30, s[52:55], s14 offen
    s_add_u32 s14, s14, 1024
    s_waitcnt vmcnt(3)
    buffer_load_dword v37, v30, s[52:55], s14 offen
    s_add_u32 s14, s14, 1024
    s_waitcnt vmcnt(3)
    buffer_load_dword v38, v30, s[52:55], s14 offen
    s_add_u32 s14, s14, 1024
    s_waitcnt vmcnt(3)
    buffer_load_dword v39, v30, s[52:55], s14 offen
    s_add_u32 s14, s14, 25600
    v_perm_b32 v152, v41, v40, s10
    v_perm_b32 v156, v41, v40, s11
    v_perm_b32 v153, v43, v42, s10
    v_perm_b32 v157, v43, v42, s11
    v_perm_b32 v154, v45, v44, s10
    v_perm_b32 v158, v45, v44, s11
    v_perm_b32 v155, v47, v46, s10
    v_perm_b32 v159, v47, v46, s11
    ds_write_b128 v31, v[152:155] offset:6144
    ds_write_b128 v31, v[156:159] offset:7168
    s_waitcnt vmcnt(3)
    buffer_load_dword v40, v30, s[52:55], s14 offen
    s_add_u32 s14, s14, 1024
    s_waitcnt vmcnt(3)
    buffer_load_dword v41, v30, s[52:55], s14 offen
    s_add_u32 s14, s14, 1024
    s_waitcnt vmcnt(3)
    buffer_load_dword v42, v30, s[52:55], s14 offen
    s_add_u32 s14, s14, 1024
    s_waitcnt vmcnt(3)
    buffer_load_dword v43, v30, s[52:55], s14 offen
    s_add_u32 s14, s14, 1024
    s_waitcnt vmcnt(3)
    buffer_load_dword v44, v30, s[52:55], s14 offen
    s_add_u32 s14, s14, 1024
    s_waitcnt vmcnt(3)
    buffer_load_dword v45, v30, s[52:55], s14 offen
    s_add_u32 s14, s14, 1024
    s_waitcnt vmcnt(3)
    buffer_load_dword v46, v30, s[52:55], s14 offen
    s_add_u32 s14, s14, 1024
    s_waitcnt vmcnt(3)
    buffer_load_dword v47, v30, s[52:55], s14 offen
    s_add_u32 s14, s14, 25600
    v_perm_b32 v144, v33, v32, s10
    v_perm_b32 v148, v33, v32, s11
    v_perm_b32 v145, v35, v34, s10
    v_perm_b32 v149, v35, v34, s11
    v_perm_b32 v146, v37, v36, s10
    v_perm_b32 v150, v37, v36, s11
    v_perm_b32 v147, v39, v38, s10
    v_perm_b32 v151, v39, v38, s11
    ds_write_b128 v31, v[144:147] offset:8192
    ds_write_b128 v31, v[148:151] offset:9216
    s_waitcnt vmcnt(3)
    buffer_load_dword v32, v30, s[52:55], s14 offen
    s_add_u32 s14, s14, 1024
    s_waitcnt vmcnt(3)
    buffer_load_dword v33, v30, s[52:55], s14 offen
    s_add_u32 s14, s14, 1024
    s_waitcnt vmcnt(3)
    buffer_load_dword v34, v30, s[52:55], s14 offen
    s_add_u32 s14, s14, 1024
    s_waitcnt vmcnt(3)
    buffer_load_dword v35, v30, s[52:55], s14 offen
    s_add_u32 s14, s14, 1024
    s_waitcnt vmcnt(3)
    buffer_load_dword v36, v30, s[52:55], s14 offen
    s_add_u32 s14, s14, 1024
    s_waitcnt vmcnt(3)
    buffer_load_dword v37, v30, s[52:55], s14 offen
    s_add_u32 s14, s14, 1024
    s_waitcnt vmcnt(3)
    buffer_load_dword v38, v30, s[52:55], s14 offen
    s_add_u32 s14, s14, 1024
    s_waitcnt vmcnt(3)
    buffer_load_dword v39, v30, s[52:55], s14 offen
    s_add_u32 s14, s14, 25600
    v_perm_b32 v152, v41, v40, s10
    v_perm_b32 v156, v41, v40, s11
    v_perm_b32 v153, v43, v42, s10
    v_perm_b32 v157, v43, v42, s11
    v_perm_b32 v154, v45, v44, s10
    v_perm_b32 v158, v45, v44, s11
    v_perm_b32 v155, v47, v46, s10
    v_perm_b32 v159, v47, v46, s11
    ds_write_b128 v31, v[152:155] offset:10240
    ds_write_b128 v31, v[156:159] offset:11264
    s_waitcnt vmcnt(3)
    buffer_load_dword v40, v30, s[52:55], s14 offen
    s_add_u32 s14, s14, 1024
    s_waitcnt vmcnt(3)
    buffer_load_dword v41, v30, s[52:55], s14 offen
    s_add_u32 s14, s14, 1024
    s_waitcnt vmcnt(3)
    buffer_load_dword v42, v30, s[52:55], s14 offen
    s_add_u32 s14, s14, 1024
    s_waitcnt vmcnt(3)
    buffer_load_dword v43, v30, s[52:55], s14 offen
    s_add_u32 s14, s14, 1024
    s_waitcnt vmcnt(3)
    buffer_load_dword v44, v30, s[52:55], s14 offen
    s_add_u32 s14, s14, 1024
    s_waitcnt vmcnt(3)
    buffer_load_dword v45, v30, s[52:55], s14 offen
    s_add_u32 s14, s14, 1024
    s_waitcnt vmcnt(3)
    buffer_load_dword v46, v30, s[52:55], s14 offen
    s_add_u32 s14, s14, 1024
    s_waitcnt vmcnt(3)
    buffer_load_dword v47, v30, s[52:55], s14 offen
    s_add_u32 s14, s14, 25600
    v_perm_b32 v144, v33, v32, s10
    v_perm_b32 v148, v33, v32, s11
    v_perm_b32 v145, v35, v34, s10
    v_perm_b32 v149, v35, v34, s11
    v_perm_b32 v146, v37, v36, s10
    v_perm_b32 v150, v37, v36, s11
    v_perm_b32 v147, v39, v38, s10
    v_perm_b32 v151, v39, v38, s11
    ds_write_b128 v31, v[144:147] offset:12288
    ds_write_b128 v31, v[148:151] offset:13312
    s_waitcnt vmcnt(3)
    buffer_load_dword v32, v30, s[52:55], s14 offen
    s_add_u32 s14, s14, 1024
    s_waitcnt vmcnt(3)
    buffer_load_dword v33, v30, s[52:55], s14 offen
    s_add_u32 s14, s14, 1024
    s_waitcnt vmcnt(3)
    buffer_load_dword v34, v30, s[52:55], s14 offen
    s_add_u32 s14, s14, 1024
    s_waitcnt vmcnt(3)
    buffer_load_dword v35, v30, s[52:55], s14 offen
    s_add_u32 s14, s14, 1024
    s_waitcnt vmcnt(3)
    buffer_load_dword v36, v30, s[52:55], s14 offen
    s_add_u32 s14, s14, 1024
    s_waitcnt vmcnt(3)
    buffer_load_dword v37, v30, s[52:55], s14 offen
    s_add_u32 s14, s14, 1024
    s_waitcnt vmcnt(3)
    buffer_load_dword v38, v30, s[52:55], s14 offen
    s_add_u32 s14, s14, 1024
    s_waitcnt vmcnt(3)
    buffer_load_dword v39, v30, s[52:55], s14 offen
    s_add_u32 s14, s14, 25600
    v_perm_b32 v152, v41, v40, s10
    v_perm_b32 v156, v41, v40, s11
    v_perm_b32 v153, v43, v42, s10
    v_perm_b32 v157, v43, v42, s11
    v_perm_b32 v154, v45, v44, s10
    v_perm_b32 v158, v45, v44, s11
    v_perm_b32 v155, v47, v46, s10
    v_perm_b32 v159, v47, v46, s11
    ds_write_b128 v31, v[152:155] offset:14336
    ds_write_b128 v31, v[156:159] offset:15360
    s_waitcnt vmcnt(3)
    buffer_load_dword v40, v30, s[52:55], s14 offen
    s_add_u32 s14, s14, 1024
    s_waitcnt vmcnt(3)
    buffer_load_dword v41, v30, s[52:55], s14 offen
    s_add_u32 s14, s14, 1024
    s_waitcnt vmcnt(3)
    buffer_load_dword v42, v30, s[52:55], s14 offen
    s_add_u32 s14, s14, 1024
    s_waitcnt vmcnt(3)
    buffer_load_dword v43, v30, s[52:55], s14 offen
    s_add_u32 s14, s14, 1024
    s_waitcnt vmcnt(3)
    buffer_load_dword v44, v30, s[52:55], s14 offen
    s_add_u32 s14, s14, 1024
    s_waitcnt vmcnt(3)
    buffer_load_dword v45, v30, s[52:55], s14 offen
    s_add_u32 s14, s14, 1024
    s_waitcnt vmcnt(3)
    buffer_load_dword v46, v30, s[52:55], s14 offen
    s_add_u32 s14, s14, 1024
    s_waitcnt vmcnt(3)
    buffer_load_dword v47, v30, s[52:55], s14 offen
    s_add_u32 s14, s14, 25600
    v_perm_b32 v144, v33, v32, s10
    v_perm_b32 v148, v33, v32, s11
    v_perm_b32 v145, v35, v34, s10
    v_perm_b32 v149, v35, v34, s11
    v_perm_b32 v146, v37, v36, s10
    v_perm_b32 v150, v37, v36, s11
    v_perm_b32 v147, v39, v38, s10
    v_perm_b32 v151, v39, v38, s11
    ds_write_b128 v31, v[144:147] offset:16384
    ds_write_b128 v31, v[148:151] offset:17408
    s_waitcnt vmcnt(3)
    buffer_load_dword v32, v30, s[52:55], s14 offen
    s_add_u32 s14, s14, 1024
    s_waitcnt vmcnt(3)
    buffer_load_dword v33, v30, s[52:55], s14 offen
    s_add_u32 s14, s14, 1024
    s_waitcnt vmcnt(3)
    buffer_load_dword v34, v30, s[52:55], s14 offen
    s_add_u32 s14, s14, 1024
    s_waitcnt vmcnt(3)
    buffer_load_dword v35, v30, s[52:55], s14 offen
    s_add_u32 s14, s14, 1024
    s_waitcnt vmcnt(3)
    buffer_load_dword v36, v30, s[52:55], s14 offen
    s_add_u32 s14, s14, 1024
    s_waitcnt vmcnt(3)
    buffer_load_dword v37, v30, s[52:55], s14 offen
    s_add_u32 s14, s14, 1024
    s_waitcnt vmcnt(3)
    buffer_load_dword v38, v30, s[52:55], s14 offen
    s_add_u32 s14, s14, 1024
    s_waitcnt vmcnt(3)
    buffer_load_dword v39, v30, s[52:55], s14 offen
    s_add_u32 s14, s14, 25600
    v_perm_b32 v152, v41, v40, s10
    v_perm_b32 v156, v41, v40, s11
    v_perm_b32 v153, v43, v42, s10
    v_perm_b32 v157, v43, v42, s11
    v_perm_b32 v154, v45, v44, s10
    v_perm_b32 v158, v45, v44, s11
    v_perm_b32 v155, v47, v46, s10
    v_perm_b32 v159, v47, v46, s11
    ds_write_b128 v31, v[152:155] offset:18432
    ds_write_b128 v31, v[156:159] offset:19456
    s_waitcnt vmcnt(3)
    buffer_load_dword v40, v30, s[52:55], s14 offen
    s_add_u32 s14, s14, 1024
    s_waitcnt vmcnt(3)
    buffer_load_dword v41, v30, s[52:55], s14 offen
    s_add_u32 s14, s14, 1024
    s_waitcnt vmcnt(3)
    buffer_load_dword v42, v30, s[52:55], s14 offen
    s_add_u32 s14, s14, 1024
    s_waitcnt vmcnt(3)
    buffer_load_dword v43, v30, s[52:55], s14 offen
    s_add_u32 s14, s14, 1024
    s_waitcnt vmcnt(3)
    buffer_load_dword v44, v30, s[52:55], s14 offen
    s_add_u32 s14, s14, 1024
    s_waitcnt vmcnt(3)
    buffer_load_dword v45, v30, s[52:55], s14 offen
    s_add_u32 s14, s14, 1024
    s_waitcnt vmcnt(3)
    buffer_load_dword v46, v30, s[52:55], s14 offen
    s_add_u32 s14, s14, 1024
    s_waitcnt vmcnt(3)
    buffer_load_dword v47, v30, s[52:55], s14 offen
    s_add_u32 s14, s14, 25600
    v_perm_b32 v144, v33, v32, s10
    v_perm_b32 v148, v33, v32, s11
    v_perm_b32 v145, v35, v34, s10
    v_perm_b32 v149, v35, v34, s11
    v_perm_b32 v146, v37, v36, s10
    v_perm_b32 v150, v37, v36, s11
    v_perm_b32 v147, v39, v38, s10
    v_perm_b32 v151, v39, v38, s11
    ds_write_b128 v31, v[144:147] offset:20480
    ds_write_b128 v31, v[148:151] offset:21504
    s_waitcnt vmcnt(3)
    buffer_load_dword v32, v30, s[52:55], s14 offen
    s_add_u32 s14, s14, 1024
    s_waitcnt vmcnt(3)
    buffer_load_dword v33, v30, s[52:55], s14 offen
    s_add_u32 s14, s14, 1024
    s_waitcnt vmcnt(3)
    buffer_load_dword v34, v30, s[52:55], s14 offen
    s_add_u32 s14, s14, 1024
    s_waitcnt vmcnt(3)
    buffer_load_dword v35, v30, s[52:55], s14 offen
    s_add_u32 s14, s14, 1024
    s_waitcnt vmcnt(3)
    buffer_load_dword v36, v30, s[52:55], s14 offen
    s_add_u32 s14, s14, 1024
    s_waitcnt vmcnt(3)
    buffer_load_dword v37, v30, s[52:55], s14 offen
    s_add_u32 s14, s14, 1024
    s_waitcnt vmcnt(3)
    buffer_load_dword v38, v30, s[52:55], s14 offen
    s_add_u32 s14, s14, 1024
    s_waitcnt vmcnt(3)
    buffer_load_dword v39, v30, s[52:55], s14 offen
    s_add_u32 s14, s14, 25600
    v_perm_b32 v152, v41, v40, s10
    v_perm_b32 v156, v41, v40, s11
    v_perm_b32 v153, v43, v42, s10
    v_perm_b32 v157, v43, v42, s11
    v_perm_b32 v154, v45, v44, s10
    v_perm_b32 v158, v45, v44, s11
    v_perm_b32 v155, v47, v46, s10
    v_perm_b32 v159, v47, v46, s11
    ds_write_b128 v31, v[152:155] offset:22528
    ds_write_b128 v31, v[156:159] offset:23552
    s_waitcnt vmcnt(3)
    buffer_load_dword v40, v30, s[52:55], s14 offen
    s_add_u32 s14, s14, 1024
    s_waitcnt vmcnt(3)
    buffer_load_dword v41, v30, s[52:55], s14 offen
    s_add_u32 s14, s14, 1024
    s_waitcnt vmcnt(3)
    buffer_load_dword v42, v30, s[52:55], s14 offen
    s_add_u32 s14, s14, 1024
    s_waitcnt vmcnt(3)
    buffer_load_dword v43, v30, s[52:55], s14 offen
    s_add_u32 s14, s14, 1024
    s_waitcnt vmcnt(3)
    buffer_load_dword v44, v30, s[52:55], s14 offen
    s_add_u32 s14, s14, 1024
    s_waitcnt vmcnt(3)
    buffer_load_dword v45, v30, s[52:55], s14 offen
    s_add_u32 s14, s14, 1024
    s_waitcnt vmcnt(3)
    buffer_load_dword v46, v30, s[52:55], s14 offen
    s_add_u32 s14, s14, 1024
    s_waitcnt vmcnt(3)
    buffer_load_dword v47, v30, s[52:55], s14 offen
    s_add_u32 s14, s14, 25600
    v_perm_b32 v144, v33, v32, s10
    v_perm_b32 v148, v33, v32, s11
    v_perm_b32 v145, v35, v34, s10
    v_perm_b32 v149, v35, v34, s11
    v_perm_b32 v146, v37, v36, s10
    v_perm_b32 v150, v37, v36, s11
    v_perm_b32 v147, v39, v38, s10
    v_perm_b32 v151, v39, v38, s11
    ds_write_b128 v31, v[144:147] offset:24576
    ds_write_b128 v31, v[148:151] offset:25600
    s_waitcnt vmcnt(0)
    v_perm_b32 v152, v41, v40, s10
    v_perm_b32 v156, v41, v40, s11
    v_perm_b32 v153, v43, v42, s10
    v_perm_b32 v157, v43, v42, s11
    v_perm_b32 v154, v45, v44, s10
    v_perm_b32 v158, v45, v44, s11
    v_perm_b32 v155, v47, v46, s10
    v_perm_b32 v159, v47, v46, s11
    ds_write_b128 v31, v[152:155] offset:26624
    ds_write_b128 v31, v[156:159] offset:27648
    s_waitcnt lgkmcnt(0)
    v_mov_b32 v2, 0
    s_mov_b64 exec, 1
    s_mov_b32 s15, 16384
POLL_7:
    buffer_load_dword v4, v2, s[64:67], 0 offen offset:68 sc1
    s_waitcnt vmcnt(0)
    v_cmp_gt_u32 vcc, 64, v4
    s_nop 3
    s_cbranch_vccz PDONE_8
    s_sub_u32 s15, s15, 1
    s_cmp_eq_u32 s15, 0
    s_cbranch_scc1 PDONE_8
    s_sleep 2
    s_branch POLL_7
PDONE_8:
    s_mov_b64 exec, -1
    v_lshrrev_b32 v2, 4, v0
    s_mov_b32 s10, 12288
    v_mul_lo_u32 v2, v2, s10
    v_and_b32 v3, 15, v0
    v_lshl_add_u32 v2, v3, 3, v2
    s_lshl_b32 s8, s13, 7
    s_add_u32 s9, s8, 4096
    buffer_load_dwordx2 v[32:33], v2, s[56:59], s9 offen sc1
    s_add_u32 s9, s8, 10240
    buffer_load_dwordx2 v[34:35], v2, s[56:59], s9 offen sc1
    s_add_u32 s9, s8, 53248
    buffer_load_dwordx2 v[36:37], v2, s[56:59], s9 offen sc1
    s_add_u32 s9, s8, 59392
    buffer_load_dwordx2 v[38:39], v2, s[56:59], s9 offen sc1
    s_add_u32 s9, s8, 102400
    buffer_load_dwordx2 v[40:41], v2, s[56:59], s9 offen sc1
    s_add_u32 s9, s8, 108544
    buffer_load_dwordx2 v[42:43], v2, s[56:59], s9 offen sc1
    s_add_u32 s9, s8, 151552
    buffer_load_dwordx2 v[44:45], v2, s[56:59], s9 offen sc1
    s_add_u32 s9, s8, 157696
    buffer_load_dwordx2 v[46:47], v2, s[56:59], s9 offen sc1
    v_lshrrev_b32 v2, 4, v0
    v_lshlrev_b32 v2, 10, v2
    v_lshl_add_u32 v14, v3, 2, v2
    s_lshl_b32 s8, s13, 6
    buffer_load_dword v15, v14, s[68:71], s8 offen
    s_waitcnt vmcnt(0)
    v_add_f32 v32, v32, v36
    v_add_f32 v40, v40, v44
    v_add_f32 v10, v32, v40
    v_add_f32 v33, v33, v37
    v_add_f32 v41, v41, v45
    v_add_f32 v11, v33, v41
    v_add_f32 v34, v34, v38
    v_add_f32 v42, v42, v46
    v_add_f32 v12, v34, v42
    v_add_f32 v35, v35, v39
    v_add_f32 v43, v43, v47
    v_add_f32 v13, v35, v43
    v_cvt_pk_bf16_f32 v2, v10, v11
    v_lshlrev_b32 v10, 16, v2
    v_and_b32 v11, 0xffff0000, v2
    v_cvt_pk_bf16_f32 v2, v12, v13
    v_lshlrev_b32 v12, 16, v2
    v_and_b32 v13, 0xffff0000, v2
H_ST:
    s_cmp_lg_u32 s4, 0
    s_cbranch_scc1 H_B3
    v_mov_b32 v3, 114688
    s_mov_b32 s15, 262144
LP_9:
    ds_read_b32 v4, v3 offset:8
    s_waitcnt lgkmcnt(0)
    v_cmp_gt_u32 vcc, 8, v4
    s_nop 3
    s_cbranch_vccz LPD_10
    s_sub_u32 s15, s15, 1
    s_cmp_eq_u32 s15, 0
    s_cbranch_scc1 LPD_10
    s_sleep 1
    s_branch LP_9
LPD_10:
    v_and_b32 v2, 7, v0
    v_lshlrev_b32 v2, 3, v2
    v_add_u32 v2, 114944, v2
    ds_read_b64 v[4:5], v2
    s_waitcnt lgkmcnt(0)
    v_mov_b32 v6, v4
    v_mov_b32 v18, v4
    s_nop 0
    v_max_f32_dpp v6, v6, v6 row_ror:4 row_mask:0xf bank_mask:0xf
    s_nop 1
    v_max_f32_dpp v6, v6, v6 row_ror:2 row_mask:0xf bank_mask:0xf
    s_nop 1
    v_max_f32_dpp v6, v6, v6 row_ror:1 row_mask:0xf bank_mask:0xf
    v_sub_f32 v4, v4, v6
    v_mul_f32 v4, s74, v4
    v_exp_f32 v4, v4
    s_nop 0
    v_mul_f32 v7, v4, v5
    s_nop 1
    v_add_f32_dpp v7, v7, v7 row_ror:4 row_mask:0xf bank_mask:0xf
    s_nop 1
    v_add_f32_dpp v7, v7, v7 row_ror:2 row_mask:0xf bank_mask:0xf
    s_nop 1
    v_add_f32_dpp v7, v7, v7 row_ror:1 row_mask:0xf bank_mask:0xf
    v_mov_b32 v2, 0
    s_mov_b64 exec, 1
    s_mov_b32 s15, 16384
POLL_11:
    buffer_load_dword v4, v2, s[64:67], 0 offen offset:132 sc1
    s_waitcnt vmcnt(0)
    v_cmp_gt_u32 vcc, 192, v4
    s_nop 3
    s_cbranch_vccz PDONE_12
    s_sub_u32 s15, s15, 1
    s_cmp_eq_u32 s15, 0
    s_cbranch_scc1 PDONE_12
    s_sleep 2
    s_branch POLL_11
PDONE_12:
    s_lshl_b32 s8, s2, 3
    s_add_u32 s8, s8, 284672
    buffer_store_dwordx2 v[6:7], v2, s[56:59], s8 offen sc1
    s_xor_b32 s8, s8, 1024
    s_mov_b32 s15, 16384
H_PP:
    buffer_load_dwordx2 v[4:5], v2, s[56:59], s8 offen sc1
    s_waitcnt vmcnt(0)
    v_max_u32 v3, v4, v5
    v_cmp_eq_u32 vcc, -1, v3
    s_nop 3
    s_cbranch_vccz H_PPD
    s_sub_u32 s15, s15, 1
    s_cmp_eq_u32 s15, 0
    s_cbranch_scc1 H_PPD
    s_sleep 8
    s_branch H_PP
H_PPD:
    v_max_f32 v16, v4, v6
    v_sub_f32 v4, v4, v16
    v_sub_f32 v6, v6, v16
    v_mul_f32 v4, s74, v4
    v_mul_f32 v6, s74, v6
    v_exp_f32 v4, v4
    v_exp_f32 v6, v6
    v_mul_f32 v4, v4, v5
    v_mul_f32 v6, v6, v7
    v_add_f32 v4, v4, v6
    v_rcp_f32 v17, v4
    s_mov_b64 exec, -1
    v_readfirstlane_b32 s8, v16
    v_readfirstlane_b32 s9, v17
    s_nop 0
    v_subrev_f32 v18, s8, v18
    v_mul_f32 v18, s74, v18
    v_exp_f32 v18, v18
    v_lshlrev_b32 v2, 2, v0
    v_add_u32 v2, 115072, v2
    v_mul_f32 v18, s9, v18
    s_mov_b64 exec, 0xff
    ds_write_b32 v2, v18
    s_mov_b64 exec, -1
    s_waitcnt lgkmcnt(0)
H_B3:
H_WO:
    s_mov_b32 s52, s24
    s_mov_b32 s53, s25
    s_mov_b32 s54, 4194304
    s_mov_b32 s55, 0x00020000
    v_lshrrev_b32 v2, 4, v0
    v_lshlrev_b32 v2, 10, v2
    v_and_b32 v3, 15, v0
    v_lshl_add_u32 v2, v3, 4, v2
    s_lshl_b32 s8, s6, 17
    s_lshl_b32 s9, s4, 8
    s_add_u32 s8, s8, s9
    buffer_load_dwordx4 v[32:35], v2, s[52:55], s8 offen
    s_add_u32 s8, s8, 0x1000
    buffer_load_dwordx4 v[36:39], v2, s[52:55], s8 offen
    s_add_u32 s8, s8, 0x1000
    s_waitcnt vmcnt(1)
    buffer_load_dwordx4 v[40:43], v2, s[52:55], s8 offen
    s_add_u32 s8, s8, 0x1000
    s_waitcnt vmcnt(1)
    buffer_load_dwordx4 v[44:47], v2, s[52:55], s8 offen
    s_add_u32 s8, s8, 0x1000
    s_waitcnt vmcnt(1)
    buffer_load_dwordx4 v[48:51], v2, s[52:55], s8 offen
    s_add_u32 s8, s8, 0x1000
    s_waitcnt vmcnt(1)
    buffer_load_dwordx4 v[52:55], v2, s[52:55], s8 offen
    s_add_u32 s8, s8, 0x1000
    s_waitcnt vmcnt(1)
    buffer_load_dwordx4 v[56:59], v2, s[52:55], s8 offen
    s_add_u32 s8, s8, 0x1000
    s_waitcnt vmcnt(1)
    buffer_load_dwordx4 v[60:63], v2, s[52:55], s8 offen
    s_add_u32 s8, s8, 0x1000
    s_waitcnt vmcnt(1)
    buffer_load_dwordx4 v[64:67], v2, s[52:55], s8 offen
    s_add_u32 s8, s8, 0x1000
    s_waitcnt vmcnt(1)
    buffer_load_dwordx4 v[68:71], v2, s[52:55], s8 offen
    s_add_u32 s8, s8, 0x1000
    s_waitcnt vmcnt(1)
    buffer_load_dwordx4 v[72:75], v2, s[52:55], s8 offen
    s_add_u32 s8, s8, 0x1000
    s_waitcnt vmcnt(1)
    buffer_load_dwordx4 v[76:79], v2, s[52:55], s8 offen
    s_add_u32 s8, s8, 0x1000
    s_waitcnt vmcnt(1)
    buffer_load_dwordx4 v[80:83], v2, s[52:55], s8 offen
    s_add_u32 s8, s8, 0x1000
    s_waitcnt vmcnt(1)
    buffer_load_dwordx4 v[84:87], v2, s[52:55], s8 offen
    s_add_u32 s8, s8, 0x1000
    s_waitcnt vmcnt(1)
    buffer_load_dwordx4 v[88:91], v2, s[52:55], s8 offen
    s_add_u32 s8, s8, 0x1000
    s_waitcnt vmcnt(1)
    buffer_load_dwordx4 v[92:95], v2, s[52:55], s8 offen
    s_add_u32 s8, s8, 0x1000
    s_waitcnt vmcnt(1)
    buffer_load_dwordx4 v[96:99], v2, s[52:55], s8 offen
    s_add_u32 s8, s8, 0x1000
    s_waitcnt vmcnt(1)
    buffer_load_dwordx4 v[100:103], v2, s[52:55], s8 offen
    s_add_u32 s8, s8, 0x1000
    s_waitcnt vmcnt(1)
    buffer_load_dwordx4 v[104:107], v2, s[52:55], s8 offen
    s_add_u32 s8, s8, 0x1000
    s_waitcnt vmcnt(1)
    buffer_load_dwordx4 v[108:111], v2, s[52:55], s8 offen
    s_add_u32 s8, s8, 0x1000
    s_waitcnt vmcnt(1)
    buffer_load_dwordx4 v[112:115], v2, s[52:55], s8 offen
    s_add_u32 s8, s8, 0x1000
    s_waitcnt vmcnt(1)
    buffer_load_dwordx4 v[116:119], v2, s[52:55], s8 offen
    s_add_u32 s8, s8, 0x1000
    s_waitcnt vmcnt(1)
    buffer_load_dwordx4 v[120:123], v2, s[52:55], s8 offen
    s_add_u32 s8, s8, 0x1000
    s_waitcnt vmcnt(1)
    buffer_load_dwordx4 v[124:127], v2, s[52:55], s8 offen
    s_add_u32 s8, s8, 0x1000
    s_waitcnt vmcnt(1)
    buffer_load_dwordx4 v[128:131], v2, s[52:55], s8 offen
    s_add_u32 s8, s8, 0x1000
    s_waitcnt vmcnt(1)
    buffer_load_dwordx4 v[132:135], v2, s[52:55], s8 offen
    s_add_u32 s8, s8, 0x1000
    s_waitcnt vmcnt(1)
    buffer_load_dwordx4 v[136:139], v2, s[52:55], s8 offen
    s_add_u32 s8, s8, 0x1000
    s_waitcnt vmcnt(1)
    buffer_load_dwordx4 v[140:143], v2, s[52:55], s8 offen
    s_add_u32 s8, s8, 0x1000
    s_waitcnt vmcnt(1)
    buffer_load_dwordx4 v[144:147], v2, s[52:55], s8 offen
    s_add_u32 s8, s8, 0x1000
    s_waitcnt vmcnt(1)
    buffer_load_dwordx4 v[148:151], v2, s[52:55], s8 offen
    s_add_u32 s8, s8, 0x1000
    s_waitcnt vmcnt(1)
    buffer_load_dwordx4 v[152:155], v2, s[52:55], s8 offen
    s_add_u32 s8, s8, 0x1000
    s_waitcnt vmcnt(1)
    buffer_load_dwordx4 v[156:159], v2, s[52:55], s8 offen
    v_and_b32 v2, 15, v0
    v_lshrrev_b32 v3, 4, v0
    v_lshl_add_u32 v2, v2, 2, v3
    v_lshlrev_b32 v2, 2, v2
    v_add_u32 v2, 117248, v2
    s_waitcnt vmcnt(0)
    s_barrier
    v_mov_b32 v3, 115072
    ds_read_b128 v[16:19], v3
    ds_read_b128 v[20:23], v3 offset:16
    ds_read2st64_b32 v[4:5], v2 offset0:0 offset1:1
    ds_read2st64_b32 v[6:7], v2 offset0:2 offset1:3
    ds_read2st64_b32 v[160:161], v2 offset0:4 offset1:5
    ds_read2st64_b32 v[162:163], v2 offset0:6 offset1:7
    s_waitcnt lgkmcnt(0)
    v_mul_f32 v4, v4, v16
    v_fmac_f32 v4, v6, v17
    v_fmac_f32 v4, v160, v18
    v_fmac_f32 v4, v162, v19
    v_mul_f32 v5, v5, v16
    v_fmac_f32 v5, v7, v17
    v_fmac_f32 v5, v161, v18
    v_fmac_f32 v5, v163, v19
    ds_read2st64_b32 v[16:17], v2 offset0:8 offset1:9
    ds_read2st64_b32 v[6:7], v2 offset0:10 offset1:11
    ds_read2st64_b32 v[160:161], v2 offset0:12 offset1:13
    ds_read2st64_b32 v[162:163], v2 offset0:14 offset1:15
    s_waitcnt lgkmcnt(0)
    v_fmac_f32 v4, v16, v20
    v_fmac_f32 v4, v6, v21
    v_fmac_f32 v4, v160, v22
    v_fmac_f32 v4, v162, v23
    v_cvt_pk_bf16_f32 v4, v4, v4
    v_fmac_f32 v5, v17, v20
    v_fmac_f32 v5, v7, v21
    v_fmac_f32 v5, v161, v22
    v_fmac_f32 v5, v163, v23
    v_cvt_pk_bf16_f32 v5, v5, v5
    v_and_b32_dpp v16, v4, v164 row_newbcast:0 row_mask:0xf bank_mask:0xf
    v_and_b32_dpp v17, v4, v165 row_newbcast:0 row_mask:0xf bank_mask:0xf
    v_and_b32_dpp v18, v4, v166 row_newbcast:0 row_mask:0xf bank_mask:0xf
    v_and_b32_dpp v19, v4, v167 row_newbcast:0 row_mask:0xf bank_mask:0xf
    s_nop 1
    v_mfma_f32_16x16x32_bf16 v[160:163], v[32:35], v[16:19], 0
    v_and_b32_dpp v20, v4, v164 row_newbcast:1 row_mask:0xf bank_mask:0xf
    v_and_b32_dpp v21, v4, v165 row_newbcast:1 row_mask:0xf bank_mask:0xf
    v_and_b32_dpp v22, v4, v166 row_newbcast:1 row_mask:0xf bank_mask:0xf
    v_and_b32_dpp v23, v4, v167 row_newbcast:1 row_mask:0xf bank_mask:0xf
    s_nop 1
    v_mfma_f32_16x16x32_bf16 v[160:163], v[36:39], v[20:23], v[160:163]
    v_and_b32_dpp v16, v4, v164 row_newbcast:2 row_mask:0xf bank_mask:0xf
    v_and_b32_dpp v17, v4, v165 row_newbcast:2 row_mask:0xf bank_mask:0xf
    v_and_b32_dpp v18, v4, v166 row_newbcast:2 row_mask:0xf bank_mask:0xf
    v_and_b32_dpp v19, v4, v167 row_newbcast:2 row_mask:0xf bank_mask:0xf
    s_nop 1
    v_mfma_f32_16x16x32_bf16 v[160:163], v[40:43], v[16:19], v[160:163]
    v_and_b32_dpp v20, v4, v164 row_newbcast:3 row_mask:0xf bank_mask:0xf
    v_and_b32_dpp v21, v4, v165 row_newbcast:3 row_mask:0xf bank_mask:0xf
    v_and_b32_dpp v22, v4, v166 row_newbcast:3 row_mask:0xf bank_mask:0xf
    v_and_b32_dpp v23, v4, v167 row_newbcast:3 row_mask:0xf bank_mask:0xf
    s_nop 1
    v_mfma_f32_16x16x32_bf16 v[160:163], v[44:47], v[20:23], v[160:163]
    v_and_b32_dpp v16, v4, v164 row_newbcast:4 row_mask:0xf bank_mask:0xf
    v_and_b32_dpp v17, v4, v165 row_newbcast:4 row_mask:0xf bank_mask:0xf
    v_and_b32_dpp v18, v4, v166 row_newbcast:4 row_mask:0xf bank_mask:0xf
    v_and_b32_dpp v19, v4, v167 row_newbcast:4 row_mask:0xf bank_mask:0xf
    s_nop 1
    v_mfma_f32_16x16x32_bf16 v[160:163], v[48:51], v[16:19], v[160:163]
    v_and_b32_dpp v20, v4, v164 row_newbcast:5 row_mask:0xf bank_mask:0xf
    v_and_b32_dpp v21, v4, v165 row_newbcast:5 row_mask:0xf bank_mask:0xf
    v_and_b32_dpp v22, v4, v166 row_newbcast:5 row_mask:0xf bank_mask:0xf
    v_and_b32_dpp v23, v4, v167 row_newbcast:5 row_mask:0xf bank_mask:0xf
    s_nop 1
    v_mfma_f32_16x16x32_bf16 v[160:163], v[52:55], v[20:23], v[160:163]
    v_and_b32_dpp v16, v4, v164 row_newbcast:6 row_mask:0xf bank_mask:0xf
    v_and_b32_dpp v17, v4, v165 row_newbcast:6 row_mask:0xf bank_mask:0xf
    v_and_b32_dpp v18, v4, v166 row_newbcast:6 row_mask:0xf bank_mask:0xf
    v_and_b32_dpp v19, v4, v167 row_newbcast:6 row_mask:0xf bank_mask:0xf
    s_nop 1
    v_mfma_f32_16x16x32_bf16 v[160:163], v[56:59], v[16:19], v[160:163]
    v_and_b32_dpp v20, v4, v164 row_newbcast:7 row_mask:0xf bank_mask:0xf
    v_and_b32_dpp v21, v4, v165 row_newbcast:7 row_mask:0xf bank_mask:0xf
    v_and_b32_dpp v22, v4, v166 row_newbcast:7 row_mask:0xf bank_mask:0xf
    v_and_b32_dpp v23, v4, v167 row_newbcast:7 row_mask:0xf bank_mask:0xf
    s_nop 1
    v_mfma_f32_16x16x32_bf16 v[160:163], v[60:63], v[20:23], v[160:163]
    v_and_b32_dpp v16, v4, v164 row_newbcast:8 row_mask:0xf bank_mask:0xf
    v_and_b32_dpp v17, v4, v165 row_newbcast:8 row_mask:0xf bank_mask:0xf
    v_and_b32_dpp v18, v4, v166 row_newbcast:8 row_mask:0xf bank_mask:0xf
    v_and_b32_dpp v19, v4, v167 row_newbcast:8 row_mask:0xf bank_mask:0xf
    s_nop 1
    v_mfma_f32_16x16x32_bf16 v[160:163], v[64:67], v[16:19], v[160:163]
    v_and_b32_dpp v20, v4, v164 row_newbcast:9 row_mask:0xf bank_mask:0xf
    v_and_b32_dpp v21, v4, v165 row_newbcast:9 row_mask:0xf bank_mask:0xf
    v_and_b32_dpp v22, v4, v166 row_newbcast:9 row_mask:0xf bank_mask:0xf
    v_and_b32_dpp v23, v4, v167 row_newbcast:9 row_mask:0xf bank_mask:0xf
    s_nop 1
    v_mfma_f32_16x16x32_bf16 v[160:163], v[68:71], v[20:23], v[160:163]
    v_and_b32_dpp v16, v4, v164 row_newbcast:10 row_mask:0xf bank_mask:0xf
    v_and_b32_dpp v17, v4, v165 row_newbcast:10 row_mask:0xf bank_mask:0xf
    v_and_b32_dpp v18, v4, v166 row_newbcast:10 row_mask:0xf bank_mask:0xf
    v_and_b32_dpp v19, v4, v167 row_newbcast:10 row_mask:0xf bank_mask:0xf
    s_nop 1
    v_mfma_f32_16x16x32_bf16 v[160:163], v[72:75], v[16:19], v[160:163]
    v_and_b32_dpp v20, v4, v164 row_newbcast:11 row_mask:0xf bank_mask:0xf
    v_and_b32_dpp v21, v4, v165 row_newbcast:11 row_mask:0xf bank_mask:0xf
    v_and_b32_dpp v22, v4, v166 row_newbcast:11 row_mask:0xf bank_mask:0xf
    v_and_b32_dpp v23, v4, v167 row_newbcast:11 row_mask:0xf bank_mask:0xf
    s_nop 1
    v_mfma_f32_16x16x32_bf16 v[160:163], v[76:79], v[20:23], v[160:163]
    v_and_b32_dpp v16, v4, v164 row_newbcast:12 row_mask:0xf bank_mask:0xf
    v_and_b32_dpp v17, v4, v165 row_newbcast:12 row_mask:0xf bank_mask:0xf
    v_and_b32_dpp v18, v4, v166 row_newbcast:12 row_mask:0xf bank_mask:0xf
    v_and_b32_dpp v19, v4, v167 row_newbcast:12 row_mask:0xf bank_mask:0xf
    s_nop 1
    v_mfma_f32_16x16x32_bf16 v[160:163], v[80:83], v[16:19], v[160:163]
    v_and_b32_dpp v20, v4, v164 row_newbcast:13 row_mask:0xf bank_mask:0xf
    v_and_b32_dpp v21, v4, v165 row_newbcast:13 row_mask:0xf bank_mask:0xf
    v_and_b32_dpp v22, v4, v166 row_newbcast:13 row_mask:0xf bank_mask:0xf
    v_and_b32_dpp v23, v4, v167 row_newbcast:13 row_mask:0xf bank_mask:0xf
    s_nop 1
    v_mfma_f32_16x16x32_bf16 v[160:163], v[84:87], v[20:23], v[160:163]
    v_and_b32_dpp v16, v4, v164 row_newbcast:14 row_mask:0xf bank_mask:0xf
    v_and_b32_dpp v17, v4, v165 row_newbcast:14 row_mask:0xf bank_mask:0xf
    v_and_b32_dpp v18, v4, v166 row_newbcast:14 row_mask:0xf bank_mask:0xf
    v_and_b32_dpp v19, v4, v167 row_newbcast:14 row_mask:0xf bank_mask:0xf
    s_nop 1
    v_mfma_f32_16x16x32_bf16 v[160:163], v[88:91], v[16:19], v[160:163]
    v_and_b32_dpp v20, v4, v164 row_newbcast:15 row_mask:0xf bank_mask:0xf
    v_and_b32_dpp v21, v4, v165 row_newbcast:15 row_mask:0xf bank_mask:0xf
    v_and_b32_dpp v22, v4, v166 row_newbcast:15 row_mask:0xf bank_mask:0xf
    v_and_b32_dpp v23, v4, v167 row_newbcast:15 row_mask:0xf bank_mask:0xf
    s_nop 1
    v_mfma_f32_16x16x32_bf16 v[160:163], v[92:95], v[20:23], v[160:163]
    v_and_b32_dpp v16, v5, v164 row_newbcast:0 row_mask:0xf bank_mask:0xf
    v_and_b32_dpp v17, v5, v165 row_newbcast:0 row_mask:0xf bank_mask:0xf
    v_and_b32_dpp v18, v5, v166 row_newbcast:0 row_mask:0xf bank_mask:0xf
    v_and_b32_dpp v19, v5, v167 row_newbcast:0 row_mask:0xf bank_mask:0xf
    s_nop 1
    v_mfma_f32_16x16x32_bf16 v[160:163], v[96:99], v[16:19], v[160:163]
    v_and_b32_dpp v20, v5, v164 row_newbcast:1 row_mask:0xf bank_mask:0xf
    v_and_b32_dpp v21, v5, v165 row_newbcast:1 row_mask:0xf bank_mask:0xf
    v_and_b32_dpp v22, v5, v166 row_newbcast:1 row_mask:0xf bank_mask:0xf
    v_and_b32_dpp v23, v5, v167 row_newbcast:1 row_mask:0xf bank_mask:0xf
    s_nop 1
    v_mfma_f32_16x16x32_bf16 v[160:163], v[100:103], v[20:23], v[160:163]
    v_and_b32_dpp v16, v5, v164 row_newbcast:2 row_mask:0xf bank_mask:0xf
    v_and_b32_dpp v17, v5, v165 row_newbcast:2 row_mask:0xf bank_mask:0xf
    v_and_b32_dpp v18, v5, v166 row_newbcast:2 row_mask:0xf bank_mask:0xf
    v_and_b32_dpp v19, v5, v167 row_newbcast:2 row_mask:0xf bank_mask:0xf
    s_nop 1
    v_mfma_f32_16x16x32_bf16 v[160:163], v[104:107], v[16:19], v[160:163]
    v_and_b32_dpp v20, v5, v164 row_newbcast:3 row_mask:0xf bank_mask:0xf
    v_and_b32_dpp v21, v5, v165 row_newbcast:3 row_mask:0xf bank_mask:0xf
    v_and_b32_dpp v22, v5, v166 row_newbcast:3 row_mask:0xf bank_mask:0xf
    v_and_b32_dpp v23, v5, v167 row_newbcast:3 row_mask:0xf bank_mask:0xf
    s_nop 1
    v_mfma_f32_16x16x32_bf16 v[160:163], v[108:111], v[20:23], v[160:163]
    v_and_b32_dpp v16, v5, v164 row_newbcast:4 row_mask:0xf bank_mask:0xf
    v_and_b32_dpp v17, v5, v165 row_newbcast:4 row_mask:0xf bank_mask:0xf
    v_and_b32_dpp v18, v5, v166 row_newbcast:4 row_mask:0xf bank_mask:0xf
    v_and_b32_dpp v19, v5, v167 row_newbcast:4 row_mask:0xf bank_mask:0xf
    s_nop 1
    v_mfma_f32_16x16x32_bf16 v[160:163], v[112:115], v[16:19], v[160:163]
    v_and_b32_dpp v20, v5, v164 row_newbcast:5 row_mask:0xf bank_mask:0xf
    v_and_b32_dpp v21, v5, v165 row_newbcast:5 row_mask:0xf bank_mask:0xf
    v_and_b32_dpp v22, v5, v166 row_newbcast:5 row_mask:0xf bank_mask:0xf
    v_and_b32_dpp v23, v5, v167 row_newbcast:5 row_mask:0xf bank_mask:0xf
    s_nop 1
    v_mfma_f32_16x16x32_bf16 v[160:163], v[116:119], v[20:23], v[160:163]
    v_and_b32_dpp v16, v5, v164 row_newbcast:6 row_mask:0xf bank_mask:0xf
    v_and_b32_dpp v17, v5, v165 row_newbcast:6 row_mask:0xf bank_mask:0xf
    v_and_b32_dpp v18, v5, v166 row_newbcast:6 row_mask:0xf bank_mask:0xf
    v_and_b32_dpp v19, v5, v167 row_newbcast:6 row_mask:0xf bank_mask:0xf
    s_nop 1
    v_mfma_f32_16x16x32_bf16 v[160:163], v[120:123], v[16:19], v[160:163]
    v_and_b32_dpp v20, v5, v164 row_newbcast:7 row_mask:0xf bank_mask:0xf
    v_and_b32_dpp v21, v5, v165 row_newbcast:7 row_mask:0xf bank_mask:0xf
    v_and_b32_dpp v22, v5, v166 row_newbcast:7 row_mask:0xf bank_mask:0xf
    v_and_b32_dpp v23, v5, v167 row_newbcast:7 row_mask:0xf bank_mask:0xf
    s_nop 1
    v_mfma_f32_16x16x32_bf16 v[160:163], v[124:127], v[20:23], v[160:163]
    v_and_b32_dpp v16, v5, v164 row_newbcast:8 row_mask:0xf bank_mask:0xf
    v_and_b32_dpp v17, v5, v165 row_newbcast:8 row_mask:0xf bank_mask:0xf
    v_and_b32_dpp v18, v5, v166 row_newbcast:8 row_mask:0xf bank_mask:0xf
    v_and_b32_dpp v19, v5, v167 row_newbcast:8 row_mask:0xf bank_mask:0xf
    s_nop 1
    v_mfma_f32_16x16x32_bf16 v[160:163], v[128:131], v[16:19], v[160:163]
    v_and_b32_dpp v20, v5, v164 row_newbcast:9 row_mask:0xf bank_mask:0xf
    v_and_b32_dpp v21, v5, v165 row_newbcast:9 row_mask:0xf bank_mask:0xf
    v_and_b32_dpp v22, v5, v166 row_newbcast:9 row_mask:0xf bank_mask:0xf
    v_and_b32_dpp v23, v5, v167 row_newbcast:9 row_mask:0xf bank_mask:0xf
    s_nop 1
    v_mfma_f32_16x16x32_bf16 v[160:163], v[132:135], v[20:23], v[160:163]
    v_and_b32_dpp v16, v5, v164 row_newbcast:10 row_mask:0xf bank_mask:0xf
    v_and_b32_dpp v17, v5, v165 row_newbcast:10 row_mask:0xf bank_mask:0xf
    v_and_b32_dpp v18, v5, v166 row_newbcast:10 row_mask:0xf bank_mask:0xf
    v_and_b32_dpp v19, v5, v167 row_newbcast:10 row_mask:0xf bank_mask:0xf
    s_nop 1
    v_mfma_f32_16x16x32_bf16 v[160:163], v[136:139], v[16:19], v[160:163]
    v_and_b32_dpp v20, v5, v164 row_newbcast:11 row_mask:0xf bank_mask:0xf
    v_and_b32_dpp v21, v5, v165 row_newbcast:11 row_mask:0xf bank_mask:0xf
    v_and_b32_dpp v22, v5, v166 row_newbcast:11 row_mask:0xf bank_mask:0xf
    v_and_b32_dpp v23, v5, v167 row_newbcast:11 row_mask:0xf bank_mask:0xf
    s_nop 1
    v_mfma_f32_16x16x32_bf16 v[160:163], v[140:143], v[20:23], v[160:163]
    v_and_b32_dpp v16, v5, v164 row_newbcast:12 row_mask:0xf bank_mask:0xf
    v_and_b32_dpp v17, v5, v165 row_newbcast:12 row_mask:0xf bank_mask:0xf
    v_and_b32_dpp v18, v5, v166 row_newbcast:12 row_mask:0xf bank_mask:0xf
    v_and_b32_dpp v19, v5, v167 row_newbcast:12 row_mask:0xf bank_mask:0xf
    s_nop 1
    v_mfma_f32_16x16x32_bf16 v[160:163], v[144:147], v[16:19], v[160:163]
    v_and_b32_dpp v20, v5, v164 row_newbcast:13 row_mask:0xf bank_mask:0xf
    v_and_b32_dpp v21, v5, v165 row_newbcast:13 row_mask:0xf bank_mask:0xf
    v_and_b32_dpp v22, v5, v166 row_newbcast:13 row_mask:0xf bank_mask:0xf
    v_and_b32_dpp v23, v5, v167 row_newbcast:13 row_mask:0xf bank_mask:0xf
    s_nop 1
    v_mfma_f32_16x16x32_bf16 v[160:163], v[148:151], v[20:23], v[160:163]
    v_and_b32_dpp v16, v5, v164 row_newbcast:14 row_mask:0xf bank_mask:0xf
    v_and_b32_dpp v17, v5, v165 row_newbcast:14 row_mask:0xf bank_mask:0xf
    v_and_b32_dpp v18, v5, v166 row_newbcast:14 row_mask:0xf bank_mask:0xf
    v_and_b32_dpp v19, v5, v167 row_newbcast:14 row_mask:0xf bank_mask:0xf
    s_nop 1
    v_mfma_f32_16x16x32_bf16 v[160:163], v[152:155], v[16:19], v[160:163]
    v_and_b32_dpp v20, v5, v164 row_newbcast:15 row_mask:0xf bank_mask:0xf
    v_and_b32_dpp v21, v5, v165 row_newbcast:15 row_mask:0xf bank_mask:0xf
    v_and_b32_dpp v22, v5, v166 row_newbcast:15 row_mask:0xf bank_mask:0xf
    v_and_b32_dpp v23, v5, v167 row_newbcast:15 row_mask:0xf bank_mask:0xf
    s_nop 1
    v_mfma_f32_16x16x32_bf16 v[160:163], v[156:159], v[20:23], v[160:163]
    s_lshl_b32 s8, s4, 9
    s_add_u32 s8, s8, 121344
    v_lshrrev_b32 v2, 4, v0
    v_lshlrev_b32 v2, 7, v2
    v_and_b32 v3, 15, v0
    v_lshl_add_u32 v2, v3, 2, v2
    v_add_u32 v2, s8, v2
    s_mov_b32 exec_lo, 0x00ff00ff
    s_mov_b32 exec_hi, 0x00ff00ff
    ds_write_b32 v2, v160 offset:0
    ds_write_b32 v2, v161 offset:32
    ds_write_b32 v2, v162 offset:64
    ds_write_b32 v2, v163 offset:96
    s_mov_b64 exec, -1
    s_waitcnt lgkmcnt(0)
    v_lshlrev_b32 v3, 2, v0
    v_add_u32 v2, s8, v3
    ds_read2st64_b32 v[4:5], v2 offset0:0 offset1:1
    s_lshl_b32 s8, s5, 11
    s_lshl_b32 s9, s4, 9
    s_add_u32 s8, s8, s9
    s_add_u32 s8, s8, 262144
    s_waitcnt lgkmcnt(0)
    buffer_atomic_add_f32 v4, v3, s[56:59], s8 offen
    buffer_atomic_add_f32 v5, v3, s[56:59], s8 offen offset:256
    s_cmp_eq_u32 s12, 0
    s_cbranch_scc1 H_NORELOAD
    v_lshlrev_b32 v3, 4, v0
    s_cmp_eq_u32 s12, 2
    s_cbranch_scc1 H_REL3
    s_lshl_b32 s9, s4, 14
    v_add_u32 v3, s9, v3
    ds_read_b128 v[32:35], v3 offset:0
    ds_read_b128 v[36:39], v3 offset:1024
    ds_read_b128 v[40:43], v3 offset:2048
    ds_read_b128 v[44:47], v3 offset:3072
    ds_read_b128 v[48:51], v3 offset:4096
    ds_read_b128 v[52:55], v3 offset:5120
    ds_read_b128 v[56:59], v3 offset:6144
    ds_read_b128 v[60:63], v3 offset:7168
    ds_read_b128 v[64:67], v3 offset:8192
    ds_read_b128 v[68:71], v3 offset:9216
    ds_read_b128 v[72:75], v3 offset:10240
    ds_read_b128 v[76:79], v3 offset:11264
    ds_read_b128 v[80:83], v3 offset:12288
    ds_read_b128 v[84:87], v3 offset:13312
    ds_read_b128 v[88:91], v3 offset:14336
    ds_read_b128 v[92:95], v3 offset:15360
    s_branch H_NORELOAD
H_REL3:
    s_mul_i32 s9, s4, 28672
    v_add_u32 v7, s9, v3
    ds_read_b128 v[88:91], v7 offset:0
    ds_read_b128 v[92:95], v7 offset:1024
    ds_read_b128 v[96:99], v7 offset:2048
    ds_read_b128 v[100:103], v7 offset:3072
    ds_read_b128 v[104:107], v7 offset:4096
    ds_read_b128 v[108:111], v7 offset:5120
    ds_read_b128 v[112:115], v7 offset:6144
    ds_read_b128 v[116:119], v7 offset:7168
    ds_read_b128 v[120:123], v7 offset:8192
    ds_read_b128 v[124:127], v7 offset:9216
    ds_read_b128 v[128:131], v7 offset:10240
    ds_read_b128 v[132:135], v7 offset:11264
    ds_read_b128 v[136:139], v7 offset:12288
    ds_read_b128 v[140:143], v7 offset:13312
    ds_read_b128 v[144:147], v7 offset:14336
    ds_read_b128 v[148:151], v7 offset:15360
    ds_read_b128 v[152:155], v7 offset:16384
    ds_read_b128 v[156:159], v7 offset:17408
H_NORELOAD:
    s_mov_b64 exec, 1
    v_mov_b32 v3, 114688
    v_mov_b32 v2, 1
    s_waitcnt vmcnt(0)
    ds_add_rtn_u32 v4, v3, v2 offset:12
    s_waitcnt lgkmcnt(0)
    v_readfirstlane_b32 s9, v4
    s_cmp_lg_u32 s9, 3
    s_nop 2
    s_cbranch_scc1 H_YX
    s_lshl_b32 s9, s5, 6
    v_mov_b32 v3, s9
    buffer_atomic_add v2, v3, s[64:67], 0 offen sc1
H_YX:
    s_cmp_eq_u32 s12, 0
    s_cbranch_scc1 H_EXIT
    s_getpc_b64 s[76:77]
CPF:
    s_mov_b64 exec, -1
    v_lshlrev_b32 v5, 6, v0
    v_min_u32 v5, END-CPF-4, v5
    v_add_co_u32 v4, vcc, s76, v5
    v_mov_b32 v5, s77
    v_addc_co_u32 v5, vcc, 0, v5, vcc
    global_load_dword v6, v[4:5], off
    s_mov_b64 exec, 1
    s_cmp_eq_u32 s12, 2
    s_cbranch_scc1 H_ST3
    s_lshl_b32 s9, s4, 6
    v_mov_b32 v2, s9
    s_mov_b32 s15, 16384
POLL_13:
    buffer_load_dword v4, v2, s[64:67], 0 offen offset:0 sc1
    s_waitcnt vmcnt(0)
    v_cmp_gt_u32 vcc, 64, v4
    s_nop 3
    s_cbranch_vccz PDONE_14
    s_sub_u32 s15, s15, 1
    s_cmp_eq_u32 s15, 0
    s_cbranch_scc1 PDONE_14
    s_sleep 2
    s_branch POLL_13
PDONE_14:
    s_mov_b64 exec, -1
    s_lshl_b32 s8, s4, 11
    s_add_u32 s8, s8, 262144
    v_lshlrev_b32 v2, 5, v0
    buffer_load_dwordx4 v[96:99], v2, s[56:59], s8 offen sc1
    buffer_load_dwordx4 v[100:103], v2, s[56:59], s8 offen offset:16 sc1
    v_lshlrev_b32 v104, 16, v8
    v_and_b32 v105, 0xffff0000, v8
    v_lshlrev_b32 v112, 16, v12
    v_and_b32 v113, 0xffff0000, v12
    v_lshlrev_b32 v120, 16, v24
    v_and_b32 v121, 0xffff0000, v24
    v_lshlrev_b32 v128, 16, v28
    v_and_b32 v129, 0xffff0000, v28
    v_lshlrev_b32 v106, 16, v9
    v_and_b32 v107, 0xffff0000, v9
    v_lshlrev_b32 v114, 16, v13
    v_and_b32 v115, 0xffff0000, v13
    v_lshlrev_b32 v122, 16, v25
    v_and_b32 v123, 0xffff0000, v25
    v_lshlrev_b32 v130, 16, v29
    v_and_b32 v131, 0xffff0000, v29
    v_lshlrev_b32 v108, 16, v10
    v_and_b32 v109, 0xffff0000, v10
    v_lshlrev_b32 v116, 16, v14
    v_and_b32 v117, 0xffff0000, v14
    v_lshlrev_b32 v124, 16, v26
    v_and_b32 v125, 0xffff0000, v26
    v_lshlrev_b32 v132, 16, v30
    v_and_b32 v133, 0xffff0000, v30
    v_lshlrev_b32 v110, 16, v11
    v_and_b32 v111, 0xffff0000, v11
    v_lshlrev_b32 v118, 16, v15
    v_and_b32 v119, 0xffff0000, v15
    v_lshlrev_b32 v126, 16, v27
    v_and_b32 v127, 0xffff0000, v27
    v_lshlrev_b32 v134, 16, v31
    v_and_b32 v135, 0xffff0000, v31
    s_waitcnt vmcnt(0)
    v_cvt_pk_bf16_f32 v2, v96, v97
    v_lshlrev_b32 v96, 16, v2
    v_and_b32 v97, 0xffff0000, v2
    v_cvt_pk_bf16_f32 v2, v98, v99
    v_lshlrev_b32 v98, 16, v2
    v_and_b32 v99, 0xffff0000, v2
    v_cvt_pk_bf16_f32 v2, v100, v101
    v_lshlrev_b32 v100, 16, v2
    v_and_b32 v101, 0xffff0000, v2
    v_cvt_pk_bf16_f32 v2, v102, v103
    v_lshlrev_b32 v102, 16, v2
    v_and_b32 v103, 0xffff0000, v2
    v_mul_f32 v96, v96, v112
    v_mul_f32 v97, v97, v113
    v_mul_f32 v98, v98, v114
    v_mul_f32 v99, v99, v115
    v_mul_f32 v100, v100, v116
    v_mul_f32 v101, v101, v117
    v_mul_f32 v102, v102, v118
    v_mul_f32 v103, v103, v119
    v_cvt_pk_bf16_f32 v2, v96, v97
    v_lshlrev_b32 v96, 16, v2
    v_and_b32 v97, 0xffff0000, v2
    v_cvt_pk_bf16_f32 v2, v98, v99
    v_lshlrev_b32 v98, 16, v2
    v_and_b32 v99, 0xffff0000, v2
    v_cvt_pk_bf16_f32 v2, v100, v101
    v_lshlrev_b32 v100, 16, v2
    v_and_b32 v101, 0xffff0000, v2
    v_cvt_pk_bf16_f32 v2, v102, v103
    v_lshlrev_b32 v102, 16, v2
    v_and_b32 v103, 0xffff0000, v2
    v_add_f32 v96, v96, v104
    v_add_f32 v97, v97, v105
    v_add_f32 v98, v98, v106
    v_add_f32 v99, v99, v107
    v_add_f32 v100, v100, v108
    v_add_f32 v101, v101, v109
    v_add_f32 v102, v102, v110
    v_add_f32 v103, v103, v111
    v_cvt_pk_bf16_f32 v2, v96, v97
    v_lshlrev_b32 v96, 16, v2
    v_and_b32 v97, 0xffff0000, v2
    v_cvt_pk_bf16_f32 v2, v98, v99
    v_lshlrev_b32 v98, 16, v2
    v_and_b32 v99, 0xffff0000, v2
    v_cvt_pk_bf16_f32 v2, v100, v101
    v_lshlrev_b32 v100, 16, v2
    v_and_b32 v101, 0xffff0000, v2
    v_cvt_pk_bf16_f32 v2, v102, v103
    v_lshlrev_b32 v102, 16, v2
    v_and_b32 v103, 0xffff0000, v2
    v_add_f32 v2, v96, v97
    v_add_f32 v2, v2, v98
    v_add_f32 v2, v2, v99
    v_add_f32 v2, v2, v100
    v_add_f32 v2, v2, v101
    v_add_f32 v2, v2, v102
    v_add_f32 v2, v2, v103
    s_nop 1
    v_add_f32_dpp v2, v2, v2 row_ror:8 row_mask:0xf bank_mask:0xf
    s_nop 1
    v_add_f32_dpp v2, v2, v2 row_ror:4 row_mask:0xf bank_mask:0xf
    s_nop 1
    v_add_f32_dpp v2, v2, v2 row_ror:2 row_mask:0xf bank_mask:0xf
    s_nop 1
    v_add_f32_dpp v2, v2, v2 row_ror:1 row_mask:0xf bank_mask:0xf
    v_mov_b32 v3, v2
    s_nop 1
    v_permlane16_swap_b32 v2, v3
    v_add_f32 v2, v2, v3
    v_mov_b32 v3, v2
    s_nop 1
    v_permlane32_swap_b32 v2, v3
    v_add_f32 v2, v2, v3
    v_mul_f32 v2, 0x3b000000, v2
    v_sub_f32 v4, v96, v2
    v_mul_f32 v6, v4, v4
    v_sub_f32 v4, v97, v2
    v_fmac_f32 v6, v4, v4
    v_sub_f32 v4, v98, v2
    v_fmac_f32 v6, v4, v4
    v_sub_f32 v4, v99, v2
    v_fmac_f32 v6, v4, v4
    v_sub_f32 v4, v100, v2
    v_fmac_f32 v6, v4, v4
    v_sub_f32 v4, v101, v2
    v_fmac_f32 v6, v4, v4
    v_sub_f32 v4, v102, v2
    v_fmac_f32 v6, v4, v4
    v_sub_f32 v4, v103, v2
    v_fmac_f32 v6, v4, v4
    s_nop 1
    v_add_f32_dpp v6, v6, v6 row_ror:8 row_mask:0xf bank_mask:0xf
    s_nop 1
    v_add_f32_dpp v6, v6, v6 row_ror:4 row_mask:0xf bank_mask:0xf
    s_nop 1
    v_add_f32_dpp v6, v6, v6 row_ror:2 row_mask:0xf bank_mask:0xf
    s_nop 1
    v_add_f32_dpp v6, v6, v6 row_ror:1 row_mask:0xf bank_mask:0xf
    v_mov_b32 v3, v6
    s_nop 1
    v_permlane16_swap_b32 v6, v3
    v_add_f32 v6, v6, v3
    v_mov_b32 v3, v6
    s_nop 1
    v_permlane32_swap_b32 v6, v3
    v_add_f32 v6, v6, v3
    v_mul_f32 v6, 0x3b000000, v6
    v_mov_b32 v5, v2
    v_cvt_pk_bf16_f32 v3, v5, v6
    v_lshlrev_b32 v5, 16, v3
    v_and_b32 v6, 0xffff0000, v3
    v_add_f32 v6, 0x3727c5ac, v6
    v_cvt_pk_bf16_f32 v6, v6, v6
    v_and_b32 v6, 0xffff0000, v6
    v_sqrt_f32 v6, v6
    s_nop 0
    v_cvt_pk_bf16_f32 v6, v6, v6
    v_and_b32 v6, 0xffff0000, v6
    v_rcp_f32 v6, v6
    v_sub_f32 v96, v96, v5
    v_sub_f32 v97, v97, v5
    v_sub_f32 v98, v98, v5
    v_sub_f32 v99, v99, v5
    v_sub_f32 v100, v100, v5
    v_sub_f32 v101, v101, v5
    v_sub_f32 v102, v102, v5
    v_sub_f32 v103, v103, v5
    v_cvt_pk_bf16_f32 v2, v96, v97
    v_lshlrev_b32 v96, 16, v2
    v_and_b32 v97, 0xffff0000, v2
    v_cvt_pk_bf16_f32 v2, v98, v99
    v_lshlrev_b32 v98, 16, v2
    v_and_b32 v99, 0xffff0000, v2
    v_cvt_pk_bf16_f32 v2, v100, v101
    v_lshlrev_b32 v100, 16, v2
    v_and_b32 v101, 0xffff0000, v2
    v_cvt_pk_bf16_f32 v2, v102, v103
    v_lshlrev_b32 v102, 16, v2
    v_and_b32 v103, 0xffff0000, v2
    v_mul_f32 v96, v96, v6
    v_mul_f32 v97, v97, v6
    v_mul_f32 v98, v98, v6
    v_mul_f32 v99, v99, v6
    v_mul_f32 v100, v100, v6
    v_mul_f32 v101, v101, v6
    v_mul_f32 v102, v102, v6
    v_mul_f32 v103, v103, v6
    v_cvt_pk_bf16_f32 v2, v96, v97
    v_lshlrev_b32 v96, 16, v2
    v_and_b32 v97, 0xffff0000, v2
    v_cvt_pk_bf16_f32 v2, v98, v99
    v_lshlrev_b32 v98, 16, v2
    v_and_b32 v99, 0xffff0000, v2
    v_cvt_pk_bf16_f32 v2, v100, v101
    v_lshlrev_b32 v100, 16, v2
    v_and_b32 v101, 0xffff0000, v2
    v_cvt_pk_bf16_f32 v2, v102, v103
    v_lshlrev_b32 v102, 16, v2
    v_and_b32 v103, 0xffff0000, v2
    v_mul_f32 v96, v96, v128
    v_mul_f32 v97, v97, v129
    v_mul_f32 v98, v98, v130
    v_mul_f32 v99, v99, v131
    v_mul_f32 v100, v100, v132
    v_mul_f32 v101, v101, v133
    v_mul_f32 v102, v102, v134
    v_mul_f32 v103, v103, v135
    v_cvt_pk_bf16_f32 v2, v96, v97
    v_lshlrev_b32 v96, 16, v2
    v_and_b32 v97, 0xffff0000, v2
    v_cvt_pk_bf16_f32 v2, v98, v99
    v_lshlrev_b32 v98, 16, v2
    v_and_b32 v99, 0xffff0000, v2
    v_cvt_pk_bf16_f32 v2, v100, v101
    v_lshlrev_b32 v100, 16, v2
    v_and_b32 v101, 0xffff0000, v2
    v_cvt_pk_bf16_f32 v2, v102, v103
    v_lshlrev_b32 v102, 16, v2
    v_and_b32 v103, 0xffff0000, v2
    v_add_f32 v96, v96, v120
    v_add_f32 v97, v97, v121
    v_add_f32 v98, v98, v122
    v_add_f32 v99, v99, v123
    v_add_f32 v100, v100, v124
    v_add_f32 v101, v101, v125
    v_add_f32 v102, v102, v126
    v_add_f32 v103, v103, v127
    v_cvt_pk_bf16_f32 v104, v96, v97
    v_cvt_pk_bf16_f32 v105, v98, v99
    v_cvt_pk_bf16_f32 v106, v100, v101
    v_cvt_pk_bf16_f32 v107, v102, v103
    s_lshl_b32 s8, s4, 10
    s_add_u32 s8, s8, 123392
    v_lshlrev_b32 v2, 4, v0
    v_add_u32 v2, s8, v2
    ds_write_b128 v2, v[104:107]
    v_and_b32 v2, 3, v0
    v_lshlrev_b32 v2, 10, v2
    v_lshrrev_b32 v3, 4, v0
    v_lshl_add_u32 v2, v3, 4, v2
    s_and_b32 s8, s4, 1
    s_lshl_b32 s8, s8, 9
    s_add_u32 s8, s8, 123392
    v_add_u32 v2, s8, v2
    s_waitcnt lgkmcnt(0)
    s_barrier
    ds_read_b128 v[96:99], v2 offset:0
    ds_read_b128 v[100:103], v2 offset:64
    ds_read_b128 v[104:107], v2 offset:128
    ds_read_b128 v[108:111], v2 offset:192
    ds_read_b128 v[112:115], v2 offset:256
    ds_read_b128 v[116:119], v2 offset:320
    ds_read_b128 v[120:123], v2 offset:384
    ds_read_b128 v[124:127], v2 offset:448
    s_waitcnt lgkmcnt(7)
    v_mfma_f32_16x16x32_bf16 v[128:131], v[96:99], v[32:35], 0
    v_mfma_f32_16x16x32_bf16 v[132:135], v[96:99], v[36:39], 0
    s_waitcnt lgkmcnt(6)
    v_mfma_f32_16x16x32_bf16 v[128:131], v[100:103], v[40:43], v[128:131]
    v_mfma_f32_16x16x32_bf16 v[132:135], v[100:103], v[44:47], v[132:135]
    s_waitcnt lgkmcnt(5)
    v_mfma_f32_16x16x32_bf16 v[128:131], v[104:107], v[48:51], v[128:131]
    v_mfma_f32_16x16x32_bf16 v[132:135], v[104:107], v[52:55], v[132:135]
    s_waitcnt lgkmcnt(4)
    v_mfma_f32_16x16x32_bf16 v[128:131], v[108:111], v[56:59], v[128:131]
    v_mfma_f32_16x16x32_bf16 v[132:135], v[108:111], v[60:63], v[132:135]
    s_waitcnt lgkmcnt(3)
    v_mfma_f32_16x16x32_bf16 v[128:131], v[112:115], v[64:67], v[128:131]
    v_mfma_f32_16x16x32_bf16 v[132:135], v[112:115], v[68:71], v[132:135]
    s_waitcnt lgkmcnt(2)
    v_mfma_f32_16x16x32_bf16 v[128:131], v[116:119], v[72:75], v[128:131]
    v_mfma_f32_16x16x32_bf16 v[132:135], v[116:119], v[76:79], v[132:135]
    s_waitcnt lgkmcnt(1)
    v_mfma_f32_16x16x32_bf16 v[128:131], v[120:123], v[80:83], v[128:131]
    v_mfma_f32_16x16x32_bf16 v[132:135], v[120:123], v[84:87], v[132:135]
    s_waitcnt lgkmcnt(0)
    v_mfma_f32_16x16x32_bf16 v[128:131], v[124:127], v[88:91], v[128:131]
    v_mfma_f32_16x16x32_bf16 v[132:135], v[124:127], v[92:95], v[132:135]
    s_lshl_b32 s8, s4, 9
    s_add_u32 s8, s8, 127488
    v_lshlrev_b32 v2, 3, v0
    v_add_u32 v2, s8, v2
    s_mov_b64 exec, 0xffff
    s_nop 2
    ds_write2_b32 v2, v128, v132 offset0:0 offset1:1
    ds_write2_b32 v2, v129, v133 offset0:32 offset1:33
    ds_write2_b32 v2, v130, v134 offset0:64 offset1:65
    ds_write2_b32 v2, v131, v135 offset0:96 offset1:97
    s_mov_b64 exec, -1
    v_lshlrev_b32 v2, 3, v0
    v_add_u32 v2, 127488, v2
    s_waitcnt lgkmcnt(0)
    s_barrier
    s_cmp_lg_u32 s4, 0
    s_cbranch_scc1 H_EXIT
    ds_read_b64 v[96:97], v2 offset:0
    ds_read_b64 v[98:99], v2 offset:512
    ds_read_b64 v[100:101], v2 offset:1024
    ds_read_b64 v[102:103], v2 offset:1536
    v_lshrrev_b32 v2, 4, v0
    s_mov_b32 s10, 3584
    v_mul_lo_u32 v2, v2, s10
    v_and_b32 v3, 15, v0
    v_lshl_add_u32 v2, v3, 2, v2
    s_lshl_b32 s8, s13, 6
    s_add_u32 s8, s8, 270336
    s_waitcnt lgkmcnt(0)
    v_add_f32 v96, v96, v98
    v_add_f32 v97, v97, v99
    v_add_f32 v100, v100, v102
    v_add_f32 v101, v101, v103
    v_cvt_pk_bf16_f32 v4, v96, v97
    v_lshlrev_b32 v96, 16, v4
    v_and_b32 v97, 0xffff0000, v4
    v_cvt_pk_bf16_f32 v4, v100, v101
    v_lshlrev_b32 v100, 16, v4
    v_and_b32 v101, 0xffff0000, v4
    v_mul_f32 v96, 0xbfb8aa3b, v96
    v_exp_f32 v96, v96
    s_nop 0
    v_add_f32 v96, 1.0, v96
    v_rcp_f32 v96, v96
    v_mul_f32 v97, 0xbfb8aa3b, v97
    v_exp_f32 v97, v97
    s_nop 0
    v_add_f32 v97, 1.0, v97
    v_rcp_f32 v97, v97
    s_nop 0
    v_cvt_pk_bf16_f32 v4, v96, v97
    v_lshlrev_b32 v96, 16, v4
    v_and_b32 v97, 0xffff0000, v4
    v_mul_f32 v96, v96, v100
    v_mul_f32 v97, v97, v101
    v_cvt_pk_bf16_f32 v96, v96, v97
    v_cmp_eq_u32 vcc, -1, v96
    s_nop 1
    v_cndmask_b32 v96, v96, v4, vcc
    buffer_store_dword v96, v2, s[56:59], s8 offen sc1
    s_branch H_EXIT
H_ST3:
    s_cmp_lg_u32 s4, 0
    s_cbranch_scc1 H_S3P
    s_mov_b64 exec, 15
    v_lshlrev_b32 v2, 6, v0
    s_mov_b32 s15, 16384
POLL_15:
    buffer_load_dword v4, v2, s[64:67], 0 offen offset:0 sc1
    s_waitcnt vmcnt(0)
    v_cmp_gt_u32 vcc, 64, v4
    s_nop 3
    s_cbranch_vccz PDONE_16
    s_sub_u32 s15, s15, 1
    s_cmp_eq_u32 s15, 0
    s_cbranch_scc1 PDONE_16
    s_sleep 2
    s_branch POLL_15
PDONE_16:
    s_mov_b64 exec, -1
    v_lshlrev_b32 v2, 1, v14
    s_lshl_b32 s8, s13, 7
    s_add_u32 s8, s8, 262144
    buffer_load_dwordx2 v[8:9], v2, s[56:59], s8 offen sc1
    s_waitcnt vmcnt(0)
    v_cvt_pk_bf16_f32 v2, v8, v9
    v_lshlrev_b32 v8, 16, v2
    v_and_b32 v9, 0xffff0000, v2
    v_mul_f32 v8, v8, v10
    v_mul_f32 v9, v9, v11
    v_cvt_pk_bf16_f32 v2, v8, v9
    v_lshlrev_b32 v8, 16, v2
    v_and_b32 v9, 0xffff0000, v2
    v_lshlrev_b32 v10, 16, v15
    v_and_b32 v11, 0xffff0000, v15
    v_add_f32 v8, v8, v10
    v_add_f32 v9, v9, v11
    v_cvt_pk_bf16_f32 v2, v8, v9
    v_lshlrev_b32 v8, 16, v2
    v_and_b32 v9, 0xffff0000, v2
H_S3P:
    s_mov_b64 exec, -1
    v_and_b32 v2, 3, v0
    s_mov_b32 s10, 3584
    v_mul_lo_u32 v2, v2, s10
    v_lshrrev_b32 v3, 4, v0
    v_lshl_add_u32 v2, v3, 4, v2
    s_mul_i32 s8, s4, 896
    s_add_u32 s8, s8, 270336
    s_mov_b32 s15, 16384
H_S3L:
    buffer_load_dwordx4 v[32:35], v2, s[56:59], s8 offen offset:0 sc1
    buffer_load_dwordx4 v[36:39], v2, s[56:59], s8 offen offset:64 sc1
    buffer_load_dwordx4 v[40:43], v2, s[56:59], s8 offen offset:128 sc1
    buffer_load_dwordx4 v[44:47], v2, s[56:59], s8 offen offset:192 sc1
    buffer_load_dwordx4 v[48:51], v2, s[56:59], s8 offen offset:256 sc1
    buffer_load_dwordx4 v[52:55], v2, s[56:59], s8 offen offset:320 sc1
    buffer_load_dwordx4 v[56:59], v2, s[56:59], s8 offen offset:384 sc1
    buffer_load_dwordx4 v[60:63], v2, s[56:59], s8 offen offset:448 sc1
    buffer_load_dwordx4 v[64:67], v2, s[56:59], s8 offen offset:512 sc1
    buffer_load_dwordx4 v[68:71], v2, s[56:59], s8 offen offset:576 sc1
    buffer_load_dwordx4 v[72:75], v2, s[56:59], s8 offen offset:640 sc1
    buffer_load_dwordx4 v[76:79], v2, s[56:59], s8 offen offset:704 sc1
    buffer_load_dwordx4 v[80:83], v2, s[56:59], s8 offen offset:768 sc1
    buffer_load_dwordx4 v[84:87], v2, s[56:59], s8 offen offset:832 sc1
    v_mov_b32 v3, 0
    s_waitcnt vmcnt(13)
    v_max3_u32 v3, v3, v32, v33
    v_max3_u32 v3, v3, v34, v35
    s_waitcnt vmcnt(12)
    v_max3_u32 v3, v3, v36, v37
    v_max3_u32 v3, v3, v38, v39
    s_waitcnt vmcnt(11)
    v_max3_u32 v3, v3, v40, v41
    v_max3_u32 v3, v3, v42, v43
    s_waitcnt vmcnt(10)
    v_max3_u32 v3, v3, v44, v45
    v_max3_u32 v3, v3, v46, v47
    s_waitcnt vmcnt(9)
    v_max3_u32 v3, v3, v48, v49
    v_max3_u32 v3, v3, v50, v51
    s_waitcnt vmcnt(8)
    v_max3_u32 v3, v3, v52, v53
    v_max3_u32 v3, v3, v54, v55
    s_waitcnt vmcnt(7)
    v_max3_u32 v3, v3, v56, v57
    v_max3_u32 v3, v3, v58, v59
    s_waitcnt vmcnt(6)
    v_max3_u32 v3, v3, v60, v61
    v_max3_u32 v3, v3, v62, v63
    s_waitcnt vmcnt(5)
    v_max3_u32 v3, v3, v64, v65
    v_max3_u32 v3, v3, v66, v67
    s_waitcnt vmcnt(4)
    v_max3_u32 v3, v3, v68, v69
    v_max3_u32 v3, v3, v70, v71
    s_waitcnt vmcnt(3)
    v_max3_u32 v3, v3, v72, v73
    v_max3_u32 v3, v3, v74, v75
    s_waitcnt vmcnt(2)
    v_max3_u32 v3, v3, v76, v77
    v_max3_u32 v3, v3, v78, v79
    s_waitcnt vmcnt(1)
    v_max3_u32 v3, v3, v80, v81
    v_max3_u32 v3, v3, v82, v83
    s_waitcnt vmcnt(0)
    v_max3_u32 v3, v3, v84, v85
    v_max3_u32 v3, v3, v86, v87
    v_cmp_eq_u32 vcc, -1, v3
    s_nop 3
    s_cbranch_vccz H_S3D
    s_sub_u32 s15, s15, 1
    s_cmp_eq_u32 s15, 0
    s_cbranch_scc1 H_S3D
    s_sleep 1
    s_branch H_S3L
H_S3D:
    v_mfma_f32_16x16x32_bf16 v[16:19], v[32:35], v[88:91], 0
    v_mfma_f32_16x16x32_bf16 v[20:23], v[32:35], v[92:95], 0
    v_mfma_f32_16x16x32_bf16 v[16:19], v[36:39], v[96:99], v[16:19]
    v_mfma_f32_16x16x32_bf16 v[20:23], v[36:39], v[100:103], v[20:23]
    v_mfma_f32_16x16x32_bf16 v[16:19], v[40:43], v[104:107], v[16:19]
    v_mfma_f32_16x16x32_bf16 v[20:23], v[40:43], v[108:111], v[20:23]
    v_mfma_f32_16x16x32_bf16 v[16:19], v[44:47], v[112:115], v[16:19]
    v_mfma_f32_16x16x32_bf16 v[20:23], v[44:47], v[116:119], v[20:23]
    v_mfma_f32_16x16x32_bf16 v[16:19], v[48:51], v[120:123], v[16:19]
    v_mfma_f32_16x16x32_bf16 v[20:23], v[48:51], v[124:127], v[20:23]
    ds_read_b128 v[88:91], v7 offset:18432
    ds_read_b128 v[92:95], v7 offset:19456
    ds_read_b128 v[96:99], v7 offset:20480
    ds_read_b128 v[100:103], v7 offset:21504
    ds_read_b128 v[104:107], v7 offset:22528
    ds_read_b128 v[108:111], v7 offset:23552
    ds_read_b128 v[112:115], v7 offset:24576
    ds_read_b128 v[116:119], v7 offset:25600
    ds_read_b128 v[120:123], v7 offset:26624
    ds_read_b128 v[124:127], v7 offset:27648
    v_mfma_f32_16x16x32_bf16 v[16:19], v[52:55], v[128:131], v[16:19]
    v_mfma_f32_16x16x32_bf16 v[20:23], v[52:55], v[132:135], v[20:23]
    v_mfma_f32_16x16x32_bf16 v[16:19], v[56:59], v[136:139], v[16:19]
    v_mfma_f32_16x16x32_bf16 v[20:23], v[56:59], v[140:143], v[20:23]
    v_mfma_f32_16x16x32_bf16 v[16:19], v[60:63], v[144:147], v[16:19]
    v_mfma_f32_16x16x32_bf16 v[20:23], v[60:63], v[148:151], v[20:23]
    v_mfma_f32_16x16x32_bf16 v[16:19], v[64:67], v[152:155], v[16:19]
    v_mfma_f32_16x16x32_bf16 v[20:23], v[64:67], v[156:159], v[20:23]
    s_waitcnt lgkmcnt(8)
    v_mfma_f32_16x16x32_bf16 v[16:19], v[68:71], v[88:91], v[16:19]
    v_mfma_f32_16x16x32_bf16 v[20:23], v[68:71], v[92:95], v[20:23]
    s_waitcnt lgkmcnt(6)
    v_mfma_f32_16x16x32_bf16 v[16:19], v[72:75], v[96:99], v[16:19]
    v_mfma_f32_16x16x32_bf16 v[20:23], v[72:75], v[100:103], v[20:23]
    s_waitcnt lgkmcnt(4)
    v_mfma_f32_16x16x32_bf16 v[16:19], v[76:79], v[104:107], v[16:19]
    v_mfma_f32_16x16x32_bf16 v[20:23], v[76:79], v[108:111], v[20:23]
    s_waitcnt lgkmcnt(2)
    v_mfma_f32_16x16x32_bf16 v[16:19], v[80:83], v[112:115], v[16:19]
    v_mfma_f32_16x16x32_bf16 v[20:23], v[80:83], v[116:119], v[20:23]
    s_waitcnt lgkmcnt(0)
    v_mfma_f32_16x16x32_bf16 v[16:19], v[84:87], v[120:123], v[16:19]
    v_mfma_f32_16x16x32_bf16 v[20:23], v[84:87], v[124:127], v[20:23]
    s_lshl_b32 s8, s4, 9
    s_add_u32 s8, s8, 127488
    v_lshlrev_b32 v2, 3, v0
    v_add_u32 v2, s8, v2
    s_mov_b64 exec, 0xffff
    s_nop 2
    ds_write2_b32 v2, v16, v20 offset0:0 offset1:1
    ds_write2_b32 v2, v17, v21 offset0:32 offset1:33
    ds_write2_b32 v2, v18, v22 offset0:64 offset1:65
    ds_write2_b32 v2, v19, v23 offset0:96 offset1:97
    s_mov_b64 exec, -1
    v_lshlrev_b32 v2, 3, v0
    v_add_u32 v2, 127488, v2
    s_waitcnt lgkmcnt(0)
    s_barrier
    s_cmp_lg_u32 s4, 0
    s_cbranch_scc1 H_EXIT
    ds_read_b64 v[96:97], v2 offset:0
    ds_read_b64 v[98:99], v2 offset:512
    ds_read_b64 v[100:101], v2 offset:1024
    ds_read_b64 v[102:103], v2 offset:1536
    s_mov_b32 s68, s38
    s_mov_b32 s69, s39
    s_mov_b32 s70, 4096
    s_mov_b32 s71, 0x00020000
    s_lshl_b32 s8, s13, 6
    s_waitcnt lgkmcnt(0)
    v_add_f32 v96, v96, v98
    v_add_f32 v97, v97, v99
    v_add_f32 v100, v100, v102
    v_add_f32 v101, v101, v103
    v_add_f32 v96, v96, v100
    v_add_f32 v97, v97, v101
    v_cvt_pk_bf16_f32 v4, v96, v97
    v_lshlrev_b32 v96, 16, v4
    v_and_b32 v97, 0xffff0000, v4
    v_mul_f32 v96, v96, v12
    v_mul_f32 v97, v97, v13
    v_cvt_pk_bf16_f32 v4, v96, v97
    v_lshlrev_b32 v96, 16, v4
    v_and_b32 v97, 0xffff0000, v4
    v_add_f32 v96, v96, v8
    v_add_f32 v97, v97, v9
    v_cvt_pk_bf16_f32 v96, v96, v97
    buffer_store_dword v96, v14, s[68:71], s8 offen
H_EXIT:
    s_waitcnt vmcnt(0)
    s_waitcnt vmcnt(0)
    s_endpgm
END:
    s_endpgm
.section .rodata,"a"
.p2align 6
.amdhsa_kernel adaLN_cond__mha_block_cached__glu_gated_glu__decode_kernel
  .amdhsa_next_free_vgpr 168
  .amdhsa_next_free_sgpr 102
  .amdhsa_accum_offset 168
  .amdhsa_group_segment_fixed_size 0
  .amdhsa_kernarg_size 112
  .amdhsa_user_sgpr_count 2
  .amdhsa_user_sgpr_kernarg_segment_ptr 1
  .amdhsa_system_sgpr_workgroup_id_x 1
.end_amdhsa_kernel
```
